```python
import torch

def _softmax(x, axis=-1):
    return torch.softmax(x, dim=axis)
def _gelu(x):
    return torch.nn.functional.gelu(x, approximate="tanh")
def _silu(x):
    return torch.nn.functional.silu(x)
def _sigmoid(x):
    return torch.sigmoid(x)
def _layernorm(x, axis=-1, eps=1e-5):
    m = x.mean(dim=axis, keepdim=True)
    v = x.var(dim=axis, keepdim=True, unbiased=False)
    return (x - m) / torch.sqrt(v + eps)
def _scatter_add(tgt, idx, src, axis=0):
    return tgt.clone().index_add_(axis, idx, src)
def _segment_sum(src, seg, n):
    out = torch.zeros((n,) + src.shape[1:], dtype=src.dtype)
    return out.index_add_(0, seg, src)
def _pad(x, pw):
    flat = tuple(v for pair in reversed(pw) for v in pair)
    return torch.nn.functional.pad(x, flat)

kernel_name = 'standalone__modern_conv_block_replknet__vision'

def setup_inputs():

    _w = (lambda a: (lambda t: t.to(torch.bfloat16) if t.is_floating_point() else t)(torch.as_tensor(a)))
    H = W = 384
    C = 96
    K = 3
    return {
        "x": _w((lambda *s: torch.randn(*s, dtype=torch.bfloat16) * 0.05)(1, H, W, C)),
        "dw_large": _w((lambda *s: torch.randn(*s, dtype=torch.bfloat16) * 0.4)(K, K, C) * (1.0 / K)),
        "dw_small": _w((lambda *s: torch.randn(*s, dtype=torch.bfloat16) * 0.4)(5, 5, C) * 0.2),
        "w1": _w((lambda *s: torch.randn(*s, dtype=torch.bfloat16) * 0.4)(C, 4 * C) * (C ** -0.5)),
        "w2": _w((lambda *s: torch.randn(*s, dtype=torch.bfloat16) * 0.1)(4 * C, C) * ((4 * C) ** -0.5)),
    }

def reference(x, dw_large, dw_small, w1, w2):
    B, H, W, C = x.shape
    Kl = dw_large.shape[0]
    pl = (Kl - 1) // 2
    xpl = _pad(x, ((0,0),(pl,pl),(pl,pl),(0,0)))
    out = torch.zeros_like(x)
    for i in range(Kl):
        for j in range(Kl):
            out = out + xpl[:, i:i+H, j:j+W, :] * dw_large[i, j][None, None, None, :]
    Ks = dw_small.shape[0]
    ps = (Ks - 1) // 2
    xps = _pad(x, ((0,0),(ps,ps),(ps,ps),(0,0)))
    for i in range(Ks):
        for j in range(Ks):
            out = out + xps[:, i:i+H, j:j+W, :] * dw_small[i, j][None, None, None, :]
    h = _layernorm(out, axis=-1)
    h = _gelu(torch.einsum('bhwc,ce->bhwe', h, w1))
    h = torch.einsum('bhwe,ec->bhwc', h, w2)
    return x + h
```

```asm
; @launch grid=(256,1,1) block=(256,1,1) lds=163840
.amdgcn_target "amdgcn-amd-amdhsa--gfx950"
.text
.globl standalone__modern_conv_block_replknet__vision_kernel
.p2align 8
.type standalone__modern_conv_block_replknet__vision_kernel,@function
standalone__modern_conv_block_replknet__vision_kernel:

    s_cmp_ge_u32 s2, 0x100
    s_cbranch_scc1 L_end
    s_load_dwordx8 s[4:11], s[0:1], 0x0
    s_load_dwordx4 s[12:15], s[0:1], 0x20
    s_getpc_b64 s[64:65]
    v_min_u32_e32 v202, 0xa3, v0
    v_lshlrev_b32_e32 v202, 7, v202
    global_load_dword v203, v202, s[64:65]
    v_lshlrev_b32_e32 v209, 4, v0
    v_mov_b32_e32 v199, v0
    v_and_b32_e32 v200, 63, v0
    v_lshrrev_b32_e32 v201, 6, v0
    s_and_b32 s59, s2, 7
    v_readfirstlane_b32 s58, v201
    s_lshl_b32 s59, s59, 5
    s_lshr_b32 s60, s2, 3
    s_add_u32 s59, s59, s60
    s_and_b32 s96, s59, 1
    s_mul_i32 s59, s59, 9
    s_lshl_b32 s60, s96, 3
    s_sub_u32 s59, s59, s60
    s_add_u32 s59, s59, 8
    v_mul_u32_u24_e32 v213, 0x556, v199
    v_lshrrev_b32_e32 v213, 14, v213
    v_mul_u32_u24_e32 v214, 52, v213
    v_lshrrev_b32_e32 v214, 8, v214
    v_mul_u32_u24_e32 v216, 5, v214
    v_sub_u32_e32 v216, v213, v216
    v_subrev_u32_e32 v215, 1, v214
    v_subrev_u32_e32 v216, 1, v216
    v_max_u32_e32 v216, v215, v216
    v_cmp_gt_u32_e64 s[64:65], 3, v216
    v_mul_u32_u24_e32 v215, 0x180, v215
    v_sub_u32_e32 v211, v209, v215
    v_subrev_u32_e32 v211, 0x480, v211
    v_cndmask_b32_e64 v211, 4.0, v211, s[64:65]
    v_add_u32_e32 v212, 0x1000, v209
    s_mov_b32 s90, 0x12c0
    s_mov_b32 s91, 0x20000
    s_mov_b32 s30, 0x6c0
    s_mov_b32 s31, 0x20000
    s_lshr_b32 s94, s58, 1
    s_and_b32 s95, s58, 1
    s_add_i32 s66, s59, -1
    s_max_i32 s66, s66, 0
    s_mul_i32 s68, s66, 0x5556
    s_lshr_b32 s68, s68, 22
    s_mul_i32 s60, s68, 0xfe501800
    s_mul_i32 s61, s66, 0x24000
    s_add_u32 s43, s60, s61
    s_add_i32 s66, s59, 0
    s_mul_i32 s69, s66, 0x5556
    s_lshr_b32 s69, s69, 22
    s_mul_i32 s60, s69, 0xfe501800
    s_mul_i32 s61, s66, 0x24000
    s_add_u32 s44, s60, s61
    s_add_i32 s66, s59, 1
    s_mul_i32 s70, s66, 0x5556
    s_lshr_b32 s70, s70, 22
    s_mul_i32 s60, s70, 0xfe501800
    s_mul_i32 s61, s66, 0x24000
    s_add_u32 s45, s60, s61
    s_mul_i32 s62, s95, 0x180
    s_mul_i32 s66, s94, 0x12000
    s_add_u32 s62, s62, s66
    v_lshlrev_b32_e32 v195, 4, v200
    v_add_u32_e32 v218, 64, v200
    s_mov_b32 s64, 0x400
    v_mul_u32_u24_e32 v218, 0x51f, v218
    s_mov_b32 s65, 0x10000008
    v_lshrrev_b32_e32 v218, 15, v218
    v_mul_u32_u24_e32 v218, 0x170, v218
    v_add3_u32 v17, v218, v195, s62
    v_cndmask_b32_e64 v17, v17, 4.0, s[64:65]
    s_mul_i32 s40, s94, 0x1c30
    s_mul_i32 s66, s95, 0xe18
    s_add_u32 s40, s40, s66
    s_mov_b32 s26, 0x1b00180
    s_mov_b32 s27, 0x20000
    s_waitcnt lgkmcnt(0)
    s_mov_b64 s[88:89], s[8:9]
    s_mov_b64 s[28:29], s[6:7]
    s_sub_u32 s24, s4, 0x180
    s_subb_u32 s25, s5, 0
    buffer_load_dwordx4 v[224:227], v209, s[88:91], 0 offen
    buffer_load_dwordx4 v[232:235], v211, s[28:31], 0 offen
    buffer_load_dwordx4 v[228:231], v212, s[88:91], 0 offen
    s_add_u32 m0, s40, 0
    s_nop 0
    buffer_load_dwordx4 v17, s[24:27], s43 offen offset:1024 nt lds
    v_add_u32_e32 v217, 0x80, v200
    s_mov_b32 s64, 0x200000
    v_mul_u32_u24_e32 v217, 0x51f, v217
    s_mov_b32 s65, 0x4000
    v_lshrrev_b32_e32 v217, 15, v217
    v_mul_u32_u24_e32 v217, 0x170, v217
    s_add_u32 m0, s40, 0x3860
    s_nop 0
    buffer_load_dwordx4 v17, s[24:27], s44 offen offset:1024 nt lds
    v_add3_u32 v18, v217, v195, s62
    v_cndmask_b32_e64 v18, v18, 4.0, s[64:65]
    v_pk_mov_b32 v[100:101], 0, 0
    v_pk_mov_b32 v[102:103], 0, 0
    v_add_u32_e32 v98, 0xe180, v209
    v_and_b32_e32 v99, 48, v209
    v_add_u32_e32 v99, 0x27e00, v99
    s_add_u32 m0, s40, 0
    s_nop 0
    buffer_load_dwordx4 v18, s[24:27], s43 offen offset:2048 nt lds
    v_add_u32_e32 v217, 0, v200
    s_mov_b32 s64, 0x1000000
    v_mul_u32_u24_e32 v217, 0x51f, v217
    s_mov_b32 s65, 0x20000
    v_lshrrev_b32_e32 v217, 15, v217
    v_mul_u32_u24_e32 v217, 0x170, v217
    v_add3_u32 v16, v217, v195, s62
    v_cndmask_b32_e64 v16, v16, 4.0, s[64:65]
    v_add_u32_e32 v218, 0xc0, v200
    s_mov_b32 s64, 0x80
    v_mul_u32_u24_e32 v218, 0x51f, v218
    s_mov_b32 s65, 0x2000001
    v_lshrrev_b32_e32 v218, 15, v218
    v_mul_u32_u24_e32 v218, 0x170, v218
    v_add3_u32 v19, v218, v195, s62
    v_cndmask_b32_e64 v19, v19, 4.0, s[64:65]
    s_mov_b32 s53, 0
    s_mov_b32 s55, 0
    s_mul_i32 s54, s95, 0xffffff00
    s_add_u32 m0, s40, 0x3860
    s_nop 0
    buffer_load_dwordx4 v18, s[24:27], s44 offen offset:2048 nt lds
    s_xor_b32 s66, s95, 1
    s_mul_i32 s52, s66, 0xffffff
    s_cmp_eq_u32 s68, 0
    s_cselect_b64 s[56:57], s[52:53], 0
    s_cmp_eq_u32 s68, 11
    s_cselect_b64 s[38:39], s[54:55], 0
    v_cndmask_b32_e64 v104, v16, 4.0, s[56:57]
    v_cndmask_b32_e64 v105, v19, 4.0, s[38:39]
    s_cmp_eq_u32 s69, 0
    s_cselect_b64 s[56:57], s[52:53], 0
    s_cmp_eq_u32 s69, 11
    s_cselect_b64 s[38:39], s[54:55], 0
    v_cndmask_b32_e64 v106, v16, 4.0, s[56:57]
    v_cndmask_b32_e64 v107, v19, 4.0, s[38:39]
    s_cmp_eq_u32 s70, 0
    s_cselect_b64 s[56:57], s[52:53], 0
    s_cmp_eq_u32 s70, 11
    s_cselect_b64 s[38:39], s[54:55], 0
    v_cndmask_b32_e64 v108, v16, 4.0, s[56:57]
    v_cndmask_b32_e64 v109, v19, 4.0, s[38:39]
    s_mov_b64 s[88:89], s[10:11]
    s_mov_b32 s90, 0x12000
    s_mov_b64 s[28:29], s[12:13]
    s_mov_b32 s30, 0x12000
    s_add_u32 m0, s40, 0
    s_nop 0
    buffer_load_dwordx4 v104, s[24:27], s43 offen nt lds
    ds_write_b128 v98, v[100:103]
    v_add_u32_e32 v217, 0, v200
    v_mul_u32_u24_e32 v218, 0x556, v217
    v_lshrrev_b32_e32 v218, 16, v218
    v_lshlrev_b32_e32 v218, 2, v218
    s_mov_b32 exec_hi, 0
    buffer_load_dwordx4 v105, s[24:27], s43 offen offset:3072 nt lds
    s_mov_b32 exec_hi, -1
    ds_write_b128 v98, v[100:103] offset:4096
    v_xor_b32_e32 v217, v218, v200
    v_lshlrev_b32_e32 v192, 4, v217
    v_add_u32_e32 v217, 64, v200
    v_mul_u32_u24_e32 v218, 0x556, v217
    s_add_u32 m0, s40, 0x3860
    s_nop 0
    buffer_load_dwordx4 v106, s[24:27], s44 offen nt lds
    ds_write_b128 v98, v[100:103] offset:8192
    v_lshrrev_b32_e32 v218, 16, v218
    v_lshlrev_b32_e32 v218, 2, v218
    v_xor_b32_e32 v217, v218, v200
    v_lshlrev_b32_e32 v193, 4, v217
    s_mov_b32 exec_hi, 0
    buffer_load_dwordx4 v107, s[24:27], s44 offen offset:3072 nt lds
    s_mov_b32 exec_hi, -1
    ds_write_b128 v98, v[100:103] offset:12288
    v_add_u32_e32 v217, 0x80, v200
    v_mul_u32_u24_e32 v218, 0x556, v217
    v_lshrrev_b32_e32 v218, 16, v218
    v_lshlrev_b32_e32 v218, 2, v218
    s_add_u32 m0, s40, 0x70c0
    s_nop 0
    buffer_load_dwordx4 v108, s[24:27], s45 offen nt lds
    ds_write_b128 v98, v[100:103] offset:16384
    v_xor_b32_e32 v217, v218, v200
    v_lshlrev_b32_e32 v194, 4, v217
    s_mul_i32 s75, s58, 0x2400
    s_mul_i32 s61, s94, 0x4800
    buffer_load_dwordx4 v17, s[24:27], s45 offen offset:1024 nt lds
    ds_write_b128 v98, v[100:103] offset:17152
    s_add_u32 s74, s75, s61
    v_lshlrev_b32_e32 v207, 5, v199
    v_lshl_add_u32 v207, v213, 4, v207
    v_mul_u32_u24_e32 v214, 0x350, v214
    buffer_load_dwordx4 v18, s[24:27], s45 offen offset:2048 nt lds
    ds_write_b128 v99, v[100:103]
    v_add_u32_e32 v207, v207, v214
    v_add_u32_e32 v207, 0xf130, v207
    v_add_u32_e32 v216, 0x100, v199
    v_min_u32_e32 v216, 0x12f, v216
    s_mov_b32 exec_hi, 0
    buffer_load_dwordx4 v109, s[24:27], s45 offen offset:3072 nt lds
    s_mov_b32 exec_hi, -1
    v_mul_u32_u24_e32 v213, 0x556, v216
    v_lshrrev_b32_e32 v213, 14, v213
    v_lshlrev_b32_e32 v208, 5, v216
    v_lshl_add_u32 v208, v213, 4, v208
    v_min_u32_e32 v210, 17, v200
    s_lshr_b32 s67, s2, 3
    s_mul_i32 s67, s67, 18
    v_add_u32_e32 v210, s67, v210
    v_lshlrev_b32_e32 v210, 7, v210
    buffer_load_dword v196, v210, s[88:91], 0 offen
    buffer_load_dword v119, v210, s[28:31], 0 offen
    v_add_u32_e32 v208, 0xfe70, v208
    v_and_b32_e32 v213, 15, v200
    v_lshrrev_b32_e32 v8, 5, v200
    v_bfe_u32 v204, v200, 4, 1
    v_and_b32_e32 v205, 3, v200
    v_bfe_u32 v216, v200, 3, 1
    v_bfe_u32 v217, v200, 2, 1
    s_mul_i32 s60, s58, 0x60
    s_add_u32 s60, s60, 0xf130
    v_lshl_add_u32 v220, v205, 2, s60
    v_mul_u32_u24_e32 v222, 0xb20, v216
    v_sub_u32_e32 v220, v220, v222
    v_mul_u32_u24_e32 v222, 0x190, v217
    v_sub_u32_e32 v220, v220, v222
    v_mul_u32_u24_e32 v222, 0x1640, v204
    v_mul_u32_u24_e32 v223, 0x320, v8
    v_add3_u32 v114, v220, v222, v223
    v_add_u32_e32 v115, 0xb20, v114
    v_add_u32_e32 v222, 0x640, v222
    v_mul_u32_u24_e32 v223, 0x320, v204
    v_add_u32_e32 v223, 0x2c80, v223
    s_mov_b32 s64, -1
    s_mov_b32 s65, 0
    v_mul_u32_u24_e32 v118, 0xb20, v8
    v_add_u32_e32 v118, 0x32c0, v118
    v_cndmask_b32_e64 v222, v223, v222, s[64:65]
    v_add_u32_e32 v116, v220, v222
    v_add_u32_e32 v117, 0xb20, v116
    v_mul_u32_u24_e32 v222, 0x190, v204
    v_add3_u32 v118, v118, v220, v222
    v_bfe_u32 v214, v200, 2, 2
    v_and_b32_e32 v215, 1, v200
    v_bfe_u32 v206, v200, 1, 1
    v_mad_u32_u24 v219, v8, 24, v214
    v_mul_u32_u24_e32 v219, 0x300, v219
    v_lshl_add_u32 v219, v215, 3, v219
    v_add_u32_e32 v219, 0x15480, v219
    v_lshl_add_u32 v220, v204, 1, v206
    s_mul_i32 s60, s95, 24
    v_add_u32_e32 v220, s60, v220
    v_lshlrev_b32_e32 v218, 2, v214
    v_add_u32_e32 v162, 0, v220
    v_xor_b32_e32 v162, v162, v218
    v_lshl_add_u32 v162, v162, 4, v219
    v_add_u32_e32 v163, 4, v220
    v_xor_b32_e32 v163, v163, v218
    v_lshl_add_u32 v163, v163, 4, v219
    v_add_u32_e32 v164, 8, v220
    v_xor_b32_e32 v164, v164, v218
    v_lshl_add_u32 v164, v164, 4, v219
    v_add_u32_e32 v165, 12, v220
    v_xor_b32_e32 v165, v165, v218
    v_lshl_add_u32 v165, v165, 4, v219
    v_add_u32_e32 v166, 16, v220
    v_xor_b32_e32 v166, v166, v218
    v_lshl_add_u32 v166, v166, 4, v219
    v_add_u32_e32 v167, 20, v220
    v_xor_b32_e32 v167, v167, v218
    v_lshl_add_u32 v167, v167, 4, v219
    s_cmp_eq_u32 s96, 1
    s_cselect_b32 s97, 0xc0, -1
    s_cselect_b32 s98, 0, 0xbf
    s_cselect_b32 s99, 2, 0xbc
    s_cselect_b32 s45, s45, s43
    s_cselect_b32 s19, 0, 0x70c0
    s_cselect_b32 s96, 1, -1
    s_mul_i32 s66, s96, 2
    s_add_i32 s66, s66, s59
    s_mul_i32 s71, s66, 0x5556
    s_lshr_b32 s71, s71, 22
    s_mul_i32 s60, s71, 0xfe501800
    s_mul_i32 s61, s66, 0x24000
    s_add_u32 s46, s60, s61
    s_cmp_eq_u32 s71, 0
    s_cselect_b64 s[56:57], s[52:53], 0
    s_cmp_eq_u32 s71, 11
    s_cselect_b64 s[38:39], s[54:55], 0
    v_cndmask_b32_e64 v110, v16, 4.0, s[56:57]
    v_cndmask_b32_e64 v111, v19, 4.0, s[38:39]
    s_waitcnt lgkmcnt(0)
    s_barrier
    s_mov_b32 s92, 0x5040100
    s_mov_b32 s93, 0x7060302
    s_waitcnt vmcnt(15)
    v_perm_b32 v240, v232, v224, s92
    v_perm_b32 v241, v232, v224, s93
    v_perm_b32 v242, v233, v225, s92
    v_perm_b32 v243, v233, v225, s93
    v_perm_b32 v244, v234, v226, s92
    v_perm_b32 v245, v234, v226, s93
    v_perm_b32 v246, v235, v227, s92
    v_perm_b32 v247, v235, v227, s93
    ds_write_b128 v207, v[240:243]
    ds_write_b128 v207, v[244:247] offset:16
    s_waitcnt vmcnt(14)
    v_and_b32_e32 v248, 0xffff, v228
    v_lshrrev_b32_e32 v249, 16, v228
    v_and_b32_e32 v250, 0xffff, v229
    v_lshrrev_b32_e32 v251, 16, v229
    v_and_b32_e32 v252, 0xffff, v230
    v_lshrrev_b32_e32 v253, 16, v230
    v_and_b32_e32 v254, 0xffff, v231
    v_lshrrev_b32_e32 v255, 16, v231
    ds_write_b128 v208, v[248:251]
    ds_write_b128 v208, v[252:255] offset:16
    s_waitcnt lgkmcnt(0)
    s_barrier
    ds_read2_b32 v[44:45], v118 offset0:0 offset1:4
    ds_read2_b32 v[46:47], v118 offset0:8 offset1:12
    ds_read2_b32 v[48:49], v118 offset0:16 offset1:20
    ds_read2_b32 a[216:217], v114 offset0:0 offset1:100
    ds_read2_b32 a[224:225], v114 offset0:4 offset1:104
    s_add_u32 m0, s40, 0xa920
    s_nop 0
    buffer_load_dwordx4 v110, s[24:27], s46 offen nt lds
    s_mul_i32 s66, s96, 4
    s_add_i32 s66, s66, s59
    s_mul_i32 s73, s66, 0x5556
    s_lshr_b32 s73, s73, 22
    s_mul_i32 s60, s73, 0xfe501800
    s_mul_i32 s61, s66, 0x24000
    s_add_u32 s48, s60, s61
    ds_read2_b32 a[232:233], v114 offset0:8 offset1:108
    ds_read2_b32 a[240:241], v114 offset0:12 offset1:112
    ds_read2_b32 a[248:249], v114 offset0:16 offset1:116
    ds_read2_b32 v[224:225], v114 offset0:20 offset1:120
    ds_read2_b32 a[218:219], v115 offset0:0 offset1:100
    buffer_load_dwordx4 v17, s[24:27], s46 offen offset:1024 nt lds
    s_mov_b32 s50, s73
    s_mul_i32 s60, s73, 0xc0
    s_sub_u32 s49, s66, s60
    v_and_b32_e32 v219, 1, v213
    v_lshrrev_b32_e32 v220, 1, v213
    v_mul_u32_u24_e32 v219, 0xe18, v219
    v_mul_u32_u24_e32 v220, 0x190, v220
    ds_read2_b32 a[226:227], v115 offset0:4 offset1:104
    ds_read2_b32 a[234:235], v115 offset0:8 offset1:108
    ds_read2_b32 a[242:243], v115 offset0:12 offset1:112
    ds_read2_b32 a[250:251], v115 offset0:16 offset1:116
    ds_read2_b32 v[226:227], v115 offset0:20 offset1:120
    buffer_load_dwordx4 v18, s[24:27], s46 offen offset:2048 nt lds
    v_add_u32_e32 v218, v219, v220
    v_add_u32_e32 v221, 1, v213
    v_and_b32_e32 v219, 1, v221
    v_lshrrev_b32_e32 v220, 1, v221
    v_mul_u32_u24_e32 v219, 0xe18, v219
    v_mul_u32_u24_e32 v220, 0x190, v220
    v_add_u32_e32 v221, v219, v220
    ds_read2_b32 a[220:221], v116 offset0:0 offset1:100
    ds_read2_b32 a[228:229], v116 offset0:4 offset1:104
    ds_read2_b32 a[236:237], v116 offset0:8 offset1:108
    ds_read2_b32 a[244:245], v116 offset0:12 offset1:112
    ds_read2_b32 a[252:253], v116 offset0:16 offset1:116
    s_mov_b32 exec_hi, 0
    buffer_load_dwordx4 v111, s[24:27], s46 offen offset:3072 nt lds
    s_mov_b32 exec_hi, -1
    v_sub_u32_e32 v5, v221, v218
    s_mul_i32 s60, s58, 48
    v_mul_u32_u24_e32 v219, 0x1c30, v204
    v_add3_u32 v4, v218, v219, s60
    v_mad_i32_i24 v6, v8, v5, v4
    v_mul_u32_u24_e32 v219, 0x1c30, v8
    v_mul_u32_u24_e32 v220, 0xc0, v204
    ds_read2_b32 v[228:229], v116 offset0:20 offset1:120
    ds_read2_b32 a[222:223], v117 offset0:0 offset1:100
    ds_read2_b32 a[230:231], v117 offset0:4 offset1:104
    ds_read2_b32 a[238:239], v117 offset0:8 offset1:108
    ds_read2_b32 a[246:247], v117 offset0:12 offset1:112
    s_add_u32 s60, s60, 0x190
    v_add3_u32 v7, v218, v219, s60
    v_add_u32_e32 v7, v7, v220
    v_add_u32_e32 v221, v221, v220
    v_mul_u32_u24_e32 v15, 0x5555, v205
    s_mov_b32 s100, 0
    s_mov_b32 s101, 0x70c0
    ds_read2_b32 a[254:255], v117 offset0:16 offset1:116
    ds_read2_b32 v[230:231], v117 offset0:20 offset1:120
    s_mov_b32 s60, 0x3860
    v_add_u32_e32 v0, s100, v4
    v_add_u32_e32 v2, s101, v6
    v_add_u32_e32 v3, s101, v7
    v_mad_i32_i24 v0, v8, s60, v0
    v_add_u32_e32 v1, v0, v5
    s_mul_i32 s42, s58, 0xc00
    s_mul_i32 s41, s94, 0x7800
    s_add_u32 s41, s41, s42
    v_add_u32_e32 v14, 0xe480, v195
    s_lshl_b32 s60, s58, 12
    v_add_u32_e32 v13, s60, v14
    s_mov_b32 s66, s59
    s_sub_u32 s59, s49, s99
    s_sub_u32 s59, s59, s96
    s_cmp_eq_u32 s59, 1
    s_cselect_b32 exec_lo, -1, 0
    s_mov_b32 exec_hi, 0
    v_mov_b32_e32 v0, 0xe180
    v_mov_b32_e32 v1, 0xe180
    s_cmp_eq_u32 s59, 0
    s_cselect_b64 exec, -1, 0
    v_mov_b32_e32 v2, 0xe180
    v_mov_b32_e32 v3, 0xe180
    s_mov_b64 exec, -1
    s_mov_b32 s59, s66
    v_pk_mov_b32 v[80:81], 0, 0
    v_pk_mov_b32 v[82:83], 0, 0
    v_pk_mov_b32 v[84:85], 0, 0
    v_pk_mov_b32 v[86:87], 0, 0
    v_pk_mov_b32 v[88:89], 0, 0
    v_pk_mov_b32 v[90:91], 0, 0
    v_pk_mov_b32 v[92:93], 0, 0
    v_pk_mov_b32 v[94:95], 0, 0
    v_pk_mov_b32 v[96:97], 0, 0
    v_pk_mov_b32 v[98:99], 0, 0
    v_pk_mov_b32 v[100:101], 0, 0
    v_pk_mov_b32 v[102:103], 0, 0
    v_lshlrev_b32_e32 v218, 4, v215
    s_mov_b32 s64, 0x33333333
    s_mov_b32 s65, 0x33333333
    s_waitcnt lgkmcnt(15)
    v_lshlrev_b32_e32 v222, 16, v44
    v_and_b32_e32 v223, 0xffff0000, v44
    v_add_f32_e32 v222, v222, v223
    v_cvt_pk_bf16_f32 v222, v222, 0
    v_lshlrev_b32_e32 v222, v218, v222
    v_cndmask_b32_e64 v32, 0, v222, s[64:65]
    v_cndmask_b32_e64 v33, v222, 0, s[64:65]
    v_lshlrev_b32_e32 v222, 16, v45
    v_and_b32_e32 v223, 0xffff0000, v45
    v_add_f32_e32 v222, v222, v223
    v_cvt_pk_bf16_f32 v222, v222, 0
    v_lshlrev_b32_e32 v222, v218, v222
    v_cndmask_b32_e64 v34, 0, v222, s[64:65]
    v_cndmask_b32_e64 v35, v222, 0, s[64:65]
    v_lshlrev_b32_e32 v222, 16, v46
    v_and_b32_e32 v223, 0xffff0000, v46
    v_add_f32_e32 v222, v222, v223
    v_cvt_pk_bf16_f32 v222, v222, 0
    v_lshlrev_b32_e32 v222, v218, v222
    v_cndmask_b32_e64 v36, 0, v222, s[64:65]
    v_cndmask_b32_e64 v37, v222, 0, s[64:65]
    v_lshlrev_b32_e32 v222, 16, v47
    v_and_b32_e32 v223, 0xffff0000, v47
    v_add_f32_e32 v222, v222, v223
    v_cvt_pk_bf16_f32 v222, v222, 0
    v_lshlrev_b32_e32 v222, v218, v222
    v_cndmask_b32_e64 v38, 0, v222, s[64:65]
    v_cndmask_b32_e64 v39, v222, 0, s[64:65]
    v_lshlrev_b32_e32 v222, 16, v48
    v_and_b32_e32 v223, 0xffff0000, v48
    v_add_f32_e32 v222, v222, v223
    v_cvt_pk_bf16_f32 v222, v222, 0
    v_lshlrev_b32_e32 v222, v218, v222
    v_cndmask_b32_e64 v40, 0, v222, s[64:65]
    v_cndmask_b32_e64 v41, v222, 0, s[64:65]
    v_lshlrev_b32_e32 v222, 16, v49
    v_and_b32_e32 v223, 0xffff0000, v49
    v_add_f32_e32 v222, v222, v223
    v_cvt_pk_bf16_f32 v222, v222, 0
    v_lshlrev_b32_e32 v222, v218, v222
    v_cndmask_b32_e64 v42, 0, v222, s[64:65]
    v_cndmask_b32_e64 v43, v222, 0, s[64:65]
    s_mul_i32 s66, s96, 3
    s_add_i32 s66, s66, s59
    s_mul_i32 s72, s66, 0x5556
    s_lshr_b32 s72, s72, 22
    s_mul_i32 s60, s72, 0xfe501800
    s_mul_i32 s61, s66, 0x24000
    s_add_u32 s47, s60, s61
    s_cmp_eq_u32 s72, 0
    s_cselect_b64 s[56:57], s[52:53], 0
    s_cmp_eq_u32 s72, 11
    s_cselect_b64 s[38:39], s[54:55], 0
    v_cndmask_b32_e64 v64, v16, 4.0, s[56:57]
    v_cndmask_b32_e64 v65, v19, 4.0, s[38:39]
    s_mov_b32 s34, 0x3eeff558
    s_mov_b32 s35, 0x3eeff558
    s_mov_b32 s36, 0x3cb61376
    s_mov_b32 s37, 0x3d423f85
    s_mov_b32 s63, 0x383ef424
    s_lshl_b32 s60, s94, 9
    s_add_u32 s60, s60, 0xe480
    v_and_b32_e32 v222, 31, v200
    v_lshlrev_b32_e32 v12, 13, v8
    v_lshl_add_u32 v12, v222, 4, v12
    v_add_u32_e32 v12, s60, v12
    v_lshl_add_u32 v219, v8, 2, v214
    v_mul_u32_u24_e32 v219, 0xc0, v219
    v_lshl_add_u32 v219, v215, 4, v219
    v_lshl_add_u32 v219, v204, 5, v219
    v_lshl_add_u32 v219, v206, 3, v219
    s_mul_i32 s60, s95, 0x1860
    s_mul_i32 s66, s95, 0x17a0
    s_add_u32 s60, s60, 0x1e480
    s_add_u32 s66, s66, 0x1e480
    v_add_u32_e32 v22, s60, v219
    v_add_u32_e32 v79, s66, v219
    s_mov_b32 s64, 0xffff
    s_mov_b32 s65, 0xffff
    v_cndmask_b32_e64 v23, v79, v22, s[64:65]
    s_mov_b32 s32, 0x409d30fc
    s_mov_b32 s33, 0x409d30fc
    s_mov_b32 s51, 8
    s_mul_i32 s60, s58, 0x3000
    s_add_u32 s60, s60, 0x12480
    v_add_u32_e32 v9, s60, v195
    s_mul_i32 s60, s94, 0x1c30
    s_mul_i32 s66, s95, 0x60
    s_add_u32 s60, s60, s66
    v_add_u32_e32 v21, s60, v221
    v_lshl_add_u32 v21, v8, 4, v21
    v_mul_u32_u24_e32 v20, 0x1840, v216
    v_bfe_u32 v222, v200, 1, 2
    s_waitcnt vmcnt(10) lgkmcnt(0)
    s_barrier
    ds_read2_b64 v[120:123], v0 offset0:0 offset1:24
    ds_read2_b64 v[124:127], v1 offset0:0 offset1:24
    v_mul_u32_u24_e32 v222, 0x310, v222
    v_lshl_add_u32 v223, v215, 1, v204
    v_mul_u32_u24_e32 v223, 0xc0, v223
    v_add3_u32 v20, v20, v222, v223
    v_lshl_add_u32 v20, v8, 4, v20
    ds_read2_b64 v[136:139], v0 offset0:1 offset1:25
    ds_read2_b64 v[140:143], v1 offset0:1 offset1:25
    s_mul_i32 s60, s94, 0x3080
    s_add_u32 s60, s60, s66
    s_add_u32 s60, s60, 0x1f080
    v_add_u32_e32 v20, s60, v20
    s_mul_i32 s60, s94, 0x12000
    ds_read2_b64 v[152:155], v0 offset0:2 offset1:26
    ds_read2_b64 v[156:159], v1 offset0:2 offset1:26
    s_mul_i32 s66, s95, 0xc00
    s_add_u32 s60, s60, s66
    s_add_u32 s20, s14, s60
    s_addc_u32 s21, s15, 0
    s_sub_u32 s20, s20, 0xe480
    s_subb_u32 s21, s21, 0
    ds_read2_b64 v[176:179], v0 offset0:3 offset1:27
    ds_read2_b64 v[180:183], v1 offset0:3 offset1:27
    s_sub_u32 s22, 0x1b0e480, s60
    s_mov_b32 s23, 0x20000
    s_mul_i32 s60, s58, 0x1840
    s_add_u32 s60, s60, 0x1e480
    v_add_u32_e32 v10, s60, v195
    ds_read2_b64 v[232:235], v0 offset0:4 offset1:28
    ds_read2_b64 v[236:239], v1 offset0:4 offset1:28
    s_xor_b32 s60, s58, 1
    s_mul_i32 s60, s60, 0x1840
    s_add_u32 s60, s60, 0x1e480
    v_add_u32_e32 v11, s60, v195
    v_lshlrev_b32_e32 v219, 4, v215
    ds_read2_b64 v[248:251], v0 offset0:5 offset1:29
    ds_read2_b64 v[252:255], v1 offset0:5 offset1:29
    v_mov_b32_e32 v222, 0x3f80
    v_lshlrev_b32_e32 v219, v219, v222
    s_mov_b32 s64, 3
    s_mov_b32 s65, 48
    v_cndmask_b32_e64 v24, 0, v219, s[64:65]
    s_waitcnt lgkmcnt(10)
    v_smfmac_f32_16x16x64_bf16 v[80:83], a[216:219], v[120:127], v15
    ds_read2_b64 v[128:131], v0 offset0:50 offset1:74
    s_waitcnt lgkmcnt(9)
    v_smfmac_f32_16x16x64_bf16 v[84:87], a[224:227], v[136:143], v15
    ds_read2_b64 v[144:147], v0 offset0:51 offset1:75
    s_mov_b32 s64, 12
    s_mov_b32 s65, 0xc0
    v_cndmask_b32_e64 v25, 0, v219, s[64:65]
    s_mov_b32 s64, 0x300
    s_mov_b32 s65, 0x3000
    s_waitcnt lgkmcnt(8)
    v_smfmac_f32_16x16x64_bf16 v[88:91], a[232:235], v[152:159], v15
    ds_read2_b64 v[168:171], v0 offset0:52 offset1:76
    s_waitcnt lgkmcnt(7)
    v_smfmac_f32_16x16x64_bf16 v[92:95], a[240:243], v[176:183], v15
    ds_read2_b64 v[184:187], v0 offset0:53 offset1:77
    v_cndmask_b32_e64 v26, 0, v219, s[64:65]
    s_mov_b32 s64, 0xc00
    s_mov_b32 s65, 0xc000
    v_cndmask_b32_e64 v27, 0, v219, s[64:65]
    s_mov_b32 s64, 0x30000
    s_waitcnt lgkmcnt(6)
    v_smfmac_f32_16x16x64_bf16 v[96:99], a[248:251], v[232:239], v15
    ds_read2_b64 v[240:243], v0 offset0:54 offset1:78
    s_waitcnt lgkmcnt(5)
    v_smfmac_f32_16x16x64_bf16 v[100:103], v[224:227], v[248:255], v15
    ds_read2_b64 v[68:71], v0 offset0:55 offset1:79
    s_mov_b32 s65, 0x300000
    v_cndmask_b32_e64 v28, 0, v219, s[64:65]
    s_mov_b32 s64, 0xc0000
    s_mov_b32 s65, 0xc00000
    v_cndmask_b32_e64 v29, 0, v219, s[64:65]
    s_mov_b32 s64, 0x3000000
    s_mov_b32 s65, 0x30000000
    v_cndmask_b32_e64 v30, 0, v219, s[64:65]
    s_mov_b32 s64, 0xc000000
    s_mov_b32 s65, 0xc0000000
    v_cndmask_b32_e64 v31, 0, v219, s[64:65]
    s_add_u32 s67, s74, 0
    s_add_u32 m0, s75, 0x1e480
    s_nop 0
    buffer_load_dwordx4 v192, s[88:91], s67 offen lds
    buffer_load_dwordx4 v193, s[88:91], s67 offen offset:1024 lds
    buffer_load_dwordx4 v194, s[88:91], s67 offen offset:2048 lds
    s_add_u32 s67, s74, 0xc00
    s_add_u32 m0, s75, 0x1f080
    s_nop 0
    buffer_load_dwordx4 v192, s[88:91], s67 offen lds
    buffer_load_dwordx4 v193, s[88:91], s67 offen offset:1024 lds
    buffer_load_dwordx4 v194, s[88:91], s67 offen offset:2048 lds
    s_waitcnt vmcnt(12) lgkmcnt(0)
    s_barrier
    ds_read2_b64 v[132:135], v2 offset0:0 offset1:24
    ds_read2_b64 v[148:151], v2 offset0:1 offset1:25
    ds_read2_b64 v[172:175], v2 offset0:2 offset1:26
    ds_read2_b64 v[188:191], v2 offset0:3 offset1:27
    ds_read2_b64 v[244:247], v2 offset0:4 offset1:28
    ds_read2_b64 v[72:75], v2 offset0:5 offset1:29
    ds_read2_b64 v[52:55], v3 offset0:0 offset1:1
    ds_read2_b64 v[56:59], v3 offset0:2 offset1:3
    ds_read2_b64 v[60:63], v3 offset0:4 offset1:5
    s_add_u32 s67, s74, 0x1800
    s_add_u32 m0, s75, 0x1fc80
    s_nop 0
    buffer_load_dwordx4 v192, s[88:91], s67 offen lds
    buffer_load_dwordx4 v193, s[88:91], s67 offen offset:1024 lds
    s_waitcnt lgkmcnt(8)
    v_smfmac_f32_16x16x64_bf16 v[80:83], a[220:223], v[128:135], v15
    s_waitcnt lgkmcnt(7)
    v_smfmac_f32_16x16x64_bf16 v[84:87], a[228:231], v[144:151], v15
    buffer_load_dwordx4 v194, s[88:91], s67 offen offset:2048 lds
    s_waitcnt lgkmcnt(6)
    v_smfmac_f32_16x16x64_bf16 v[88:91], a[236:239], v[168:175], v15
    s_waitcnt lgkmcnt(5)
    v_smfmac_f32_16x16x64_bf16 v[92:95], a[244:247], v[184:191], v15
    s_add_u32 s67, s74, 0x4800
    s_add_u32 m0, s75, 0x15480
    s_nop 0
    buffer_load_dwordx4 v192, s[88:91], s67 offen lds
    s_waitcnt lgkmcnt(4)
    v_smfmac_f32_16x16x64_bf16 v[96:99], a[252:255], v[240:247], v15
    s_waitcnt lgkmcnt(3)
    v_smfmac_f32_16x16x64_bf16 v[100:103], v[228:231], v[68:75], v15
    buffer_load_dwordx4 v193, s[88:91], s67 offen offset:1024 lds
    s_waitcnt lgkmcnt(2)
    v_mfma_f32_16x16x16_bf16 v[80:83], v[32:33], v[52:53], v[80:83]
    v_mfma_f32_16x16x16_bf16 v[84:87], v[34:35], v[54:55], v[84:87]
    s_waitcnt lgkmcnt(1)
    v_mfma_f32_16x16x16_bf16 v[88:91], v[36:37], v[56:57], v[88:91]
    v_mfma_f32_16x16x16_bf16 v[92:95], v[38:39], v[58:59], v[92:95]
    s_waitcnt lgkmcnt(0)
    v_mfma_f32_16x16x16_bf16 v[96:99], v[40:41], v[60:61], v[96:99]
    v_mfma_f32_16x16x16_bf16 v[100:103], v[42:43], v[62:63], v[100:103]
    buffer_load_dwordx4 v194, s[88:91], s67 offen offset:2048 lds
    v_pk_add_f32 v[72:73], v[80:81], v[82:83]
    v_pk_mul_f32 v[74:75], v[80:81], v[80:81]
    v_pk_fma_f32 v[74:75], v[82:83], v[82:83], v[74:75]
    v_pk_add_f32 v[72:73], v[72:73], v[84:85]
    v_pk_fma_f32 v[74:75], v[84:85], v[84:85], v[74:75]
    v_pk_add_f32 v[72:73], v[72:73], v[86:87]
    v_pk_fma_f32 v[74:75], v[86:87], v[86:87], v[74:75]
    v_pk_add_f32 v[72:73], v[72:73], v[88:89]
    s_add_u32 s67, s74, 0x5400
    s_add_u32 m0, s75, 0x16080
    s_nop 0
    buffer_load_dwordx4 v192, s[88:91], s67 offen lds
    v_pk_fma_f32 v[74:75], v[88:89], v[88:89], v[74:75]
    v_pk_add_f32 v[72:73], v[72:73], v[90:91]
    v_pk_fma_f32 v[74:75], v[90:91], v[90:91], v[74:75]
    v_pk_add_f32 v[72:73], v[72:73], v[92:93]
    v_pk_fma_f32 v[74:75], v[92:93], v[92:93], v[74:75]
    v_pk_add_f32 v[72:73], v[72:73], v[94:95]
    v_pk_fma_f32 v[74:75], v[94:95], v[94:95], v[74:75]
    v_pk_add_f32 v[72:73], v[72:73], v[96:97]
    buffer_load_dwordx4 v193, s[88:91], s67 offen offset:1024 lds
    v_pk_fma_f32 v[74:75], v[96:97], v[96:97], v[74:75]
    v_pk_add_f32 v[72:73], v[72:73], v[98:99]
    v_pk_fma_f32 v[74:75], v[98:99], v[98:99], v[74:75]
    v_pk_add_f32 v[72:73], v[72:73], v[100:101]
    v_pk_fma_f32 v[74:75], v[100:101], v[100:101], v[74:75]
    v_pk_add_f32 v[72:73], v[72:73], v[102:103]
    v_pk_fma_f32 v[74:75], v[102:103], v[102:103], v[74:75]
    v_add_f32_e32 v72, v72, v73
    v_add_f32_e32 v73, v74, v75
    ds_write_b64 v13, v[72:73] offset:3072
    buffer_load_dwordx4 v194, s[88:91], s67 offen offset:2048 lds
    s_add_u32 s67, s74, 0x6000
    s_add_u32 m0, s75, 0x16c80
    s_nop 0
    buffer_load_dwordx4 v192, s[88:91], s67 offen lds
    buffer_load_dwordx4 v193, s[88:91], s67 offen offset:1024 lds
    buffer_load_dwordx4 v194, s[88:91], s67 offen offset:2048 lds
    s_waitcnt vmcnt(9) lgkmcnt(0)
    s_barrier
    ds_read2st64_b64 v[44:47], v14 offset0:6 offset1:14
    ds_read2st64_b64 v[48:51], v14 offset0:22 offset1:30
    ds_read_b64_tr_b16 a[0:1], v162 offset:36864
    ds_read_b64_tr_b16 a[2:3], v162 offset:39936
    ds_read_b64_tr_b16 a[4:5], v162 offset:43008
    ds_read_b64_tr_b16 a[6:7], v162 offset:46080
    ds_read_b64_tr_b16 a[8:9], v162 offset:49152
    ds_read_b64_tr_b16 a[10:11], v162 offset:52224
    ds_read_b64_tr_b16 a[24:25], v163 offset:36864
    ds_read_b64_tr_b16 a[26:27], v163 offset:39936
    ds_read_b64_tr_b16 a[28:29], v163 offset:43008
    ds_read_b64_tr_b16 a[30:31], v163 offset:46080
    ds_read_b64_tr_b16 a[32:33], v163 offset:49152
    ds_read_b64_tr_b16 a[34:35], v163 offset:52224
    s_waitcnt lgkmcnt(13)
    v_pk_add_f32 v[72:73], v[44:45], v[46:47]
    s_waitcnt lgkmcnt(12)
    v_pk_add_f32 v[74:75], v[48:49], v[50:51]
    v_pk_add_f32 v[72:73], v[72:73], v[74:75]
    v_pk_mul_f32 v[72:73], v[72:73], s[36:37]
    v_fma_f32 v73, -v72, v72, v73
    ds_read_b64_tr_b16 a[48:49], v164 offset:36864
    ds_read_b64_tr_b16 a[50:51], v164 offset:39936
    ds_read_b64_tr_b16 a[52:53], v164 offset:43008
    ds_read_b64_tr_b16 a[54:55], v164 offset:46080
    v_max_f32_e32 v73, 0, v73
    v_add_f32_e32 v73, s63, v73
    v_mul_f32_e32 v72, s34, v72
    v_rsq_f32_e32 v76, v73
    s_nop 0
    v_mul_f32_e64 v77, -v72, v76
    ds_read_b64_tr_b16 a[56:57], v164 offset:49152
    ds_read_b64_tr_b16 a[58:59], v164 offset:52224
    ds_read_b64_tr_b16 a[72:73], v165 offset:36864
    ds_read_b64_tr_b16 a[74:75], v165 offset:39936
    v_pk_fma_f32 v[80:81], v[80:81], v[76:77], v[76:77] op_sel:[0,0,1] op_sel_hi:[1,0,1]
    v_pk_fma_f32 v[82:83], v[82:83], v[76:77], v[76:77] op_sel:[0,0,1] op_sel_hi:[1,0,1]
    v_pk_fma_f32 v[84:85], v[84:85], v[76:77], v[76:77] op_sel:[0,0,1] op_sel_hi:[1,0,1]
    v_pk_fma_f32 v[86:87], v[86:87], v[76:77], v[76:77] op_sel:[0,0,1] op_sel_hi:[1,0,1]
    v_pk_fma_f32 v[88:89], v[88:89], v[76:77], v[76:77] op_sel:[0,0,1] op_sel_hi:[1,0,1]
    ds_read_b64_tr_b16 a[76:77], v165 offset:43008
    ds_read_b64_tr_b16 a[78:79], v165 offset:46080
    ds_read_b64_tr_b16 a[80:81], v165 offset:49152
    ds_read_b64_tr_b16 a[82:83], v165 offset:52224
    v_pk_fma_f32 v[90:91], v[90:91], v[76:77], v[76:77] op_sel:[0,0,1] op_sel_hi:[1,0,1]
    v_pk_fma_f32 v[92:93], v[92:93], v[76:77], v[76:77] op_sel:[0,0,1] op_sel_hi:[1,0,1]
    v_pk_fma_f32 v[94:95], v[94:95], v[76:77], v[76:77] op_sel:[0,0,1] op_sel_hi:[1,0,1]
    v_pk_fma_f32 v[96:97], v[96:97], v[76:77], v[76:77] op_sel:[0,0,1] op_sel_hi:[1,0,1]
    v_pk_fma_f32 v[98:99], v[98:99], v[76:77], v[76:77] op_sel:[0,0,1] op_sel_hi:[1,0,1]
    ds_read_b64_tr_b16 a[96:97], v166 offset:36864
    ds_read_b64_tr_b16 a[98:99], v166 offset:39936
    ds_read_b64_tr_b16 a[100:101], v166 offset:43008
    ds_read_b64_tr_b16 a[102:103], v166 offset:46080
    v_pk_fma_f32 v[100:101], v[100:101], v[76:77], v[76:77] op_sel:[0,0,1] op_sel_hi:[1,0,1]
    v_pk_fma_f32 v[102:103], v[102:103], v[76:77], v[76:77] op_sel:[0,0,1] op_sel_hi:[1,0,1]
    v_cvt_pk_bf16_f32 v80, v80, v81
    v_cvt_pk_bf16_f32 v81, v82, v83
    v_cvt_pk_bf16_f32 v82, v84, v85
    ds_read_b64_tr_b16 a[104:105], v166 offset:49152
    ds_read_b64_tr_b16 a[106:107], v166 offset:52224
    ds_read_b64_tr_b16 a[120:121], v167 offset:36864
    ds_read_b64_tr_b16 a[122:123], v167 offset:39936
    v_cvt_pk_bf16_f32 v83, v86, v87
    v_cvt_pk_bf16_f32 v84, v88, v89
    v_cvt_pk_bf16_f32 v85, v90, v91
    v_cvt_pk_bf16_f32 v86, v92, v93
    v_cvt_pk_bf16_f32 v87, v94, v95
    ds_read_b64_tr_b16 a[124:125], v167 offset:43008
    ds_read_b64_tr_b16 a[126:127], v167 offset:46080
    ds_read_b64_tr_b16 a[128:129], v167 offset:49152
    ds_read_b64_tr_b16 a[130:131], v167 offset:52224
    v_cvt_pk_bf16_f32 v88, v96, v97
    v_cvt_pk_bf16_f32 v89, v98, v99
    v_cvt_pk_bf16_f32 v90, v100, v101
    v_cvt_pk_bf16_f32 v91, v102, v103
    ds_write_b128 v13, v[80:83]
    ds_write_b128 v13, v[84:87] offset:1024
    ds_write_b128 v13, v[88:91] offset:2048
    s_mov_b32 s16, 0x3860
    s_sub_u32 s17, 0x70c0, s19
    s_mov_b32 s18, 0xa920
    s_mov_b32 s80, 0x24580
    s_lshl_b32 s75, s58, 2
    s_add_u32 s75, s75, 0x27e00
    s_mul_i32 s61, s96, 0xfe525800
    s_mul_i32 s62, s96, 0x24000
    s_waitcnt vmcnt(0) lgkmcnt(0)
    s_barrier
    ds_read_b128 v[104:107], v12
    ds_read_b128 v[108:111], v12 offset:1024
    ds_read_b128 v[112:115], v12 offset:2048
    ds_read_b128 v[116:119], v12 offset:4096
    ds_read_b128 v[120:123], v12 offset:5120
    ds_read_b128 v[124:127], v12 offset:6144
    ds_read_b64_tr_b16 a[12:13], v162
    ds_read_b64_tr_b16 a[14:15], v162 offset:3072
    ds_read_b64_tr_b16 a[16:17], v162 offset:6144
    ds_read_b64_tr_b16 a[18:19], v162 offset:9216
    ds_read_b64_tr_b16 a[20:21], v162 offset:12288
    ds_read_b64_tr_b16 a[22:23], v162 offset:15360
    s_add_u32 s67, s41, 0
    s_add_u32 m0, s42, 0x1e480
    s_nop 0
    buffer_load_dwordx4 v195, s[28:31], s67 offen lds
    ds_read_b64_tr_b16 a[36:37], v163
    ds_read_b64_tr_b16 a[38:39], v163 offset:3072
    ds_read_b64_tr_b16 a[40:41], v163 offset:6144
    ds_read_b64_tr_b16 a[42:43], v163 offset:9216
    ds_read_b64_tr_b16 a[44:45], v163 offset:12288
    ds_read_b64_tr_b16 a[46:47], v163 offset:15360
    buffer_load_dwordx4 v195, s[28:31], s67 offen offset:1024 lds
    buffer_load_dwordx4 v195, s[28:31], s67 offen offset:2048 lds
    s_waitcnt lgkmcnt(15)
    v_mfma_f32_32x32x16_bf16 v[144:159], a[0:3], v[104:107], 0
    ds_read_b64_tr_b16 a[60:61], v164
    ds_read_b64_tr_b16 a[62:63], v164 offset:3072
    ds_read_b64_tr_b16 a[64:65], v164 offset:6144
    ds_read_b64_tr_b16 a[66:67], v164 offset:9216
    s_add_u32 s67, s41, 0x1800
    s_add_u32 m0, s42, 0x21480
    s_nop 0
    buffer_load_dwordx4 v195, s[28:31], s67 offen lds
    v_mfma_f32_32x32x16_bf16 v[144:159], a[4:7], v[108:111], v[144:159]
    ds_read_b64_tr_b16 a[68:69], v164 offset:12288
    ds_read_b64_tr_b16 a[70:71], v164 offset:15360
    ds_read_b64_tr_b16 a[84:85], v165
    ds_read_b64_tr_b16 a[86:87], v165 offset:3072
    buffer_load_dwordx4 v195, s[28:31], s67 offen offset:1024 lds
    v_mfma_f32_32x32x16_bf16 v[144:159], a[8:11], v[112:115], v[144:159]
    ds_read_b64_tr_b16 a[88:89], v165 offset:6144
    ds_read_b64_tr_b16 a[90:91], v165 offset:9216
    ds_read_b64_tr_b16 a[92:93], v165 offset:12288
    ds_read_b64_tr_b16 a[94:95], v165 offset:15360
    buffer_load_dwordx4 v195, s[28:31], s67 offen offset:2048 lds
    s_waitcnt lgkmcnt(15)
    v_mfma_f32_32x32x16_bf16 v[144:159], a[12:15], v[116:119], v[144:159]
    ds_read_b64_tr_b16 a[108:109], v166
    ds_read_b64_tr_b16 a[110:111], v166 offset:3072
    ds_read_b64_tr_b16 a[112:113], v166 offset:6144
    ds_read_b64_tr_b16 a[114:115], v166 offset:9216
    s_add_u32 s67, s41, 0x3000
    s_add_u32 m0, s42, 0x24480
    s_nop 0
    buffer_load_dwordx4 v195, s[28:31], s67 offen lds
    v_mfma_f32_32x32x16_bf16 v[144:159], a[16:19], v[120:123], v[144:159]
    ds_read_b64_tr_b16 a[116:117], v166 offset:12288
    ds_read_b64_tr_b16 a[118:119], v166 offset:15360
    ds_read_b64_tr_b16 a[132:133], v167
    ds_read_b64_tr_b16 a[134:135], v167 offset:3072
    buffer_load_dwordx4 v195, s[28:31], s67 offen offset:1024 lds
    v_mfma_f32_32x32x16_bf16 v[144:159], a[20:23], v[124:127], v[144:159]
    ds_read_b64_tr_b16 a[136:137], v167 offset:6144
    ds_read_b64_tr_b16 a[138:139], v167 offset:9216
    ds_read_b64_tr_b16 a[140:141], v167 offset:12288
    ds_read_b64_tr_b16 a[142:143], v167 offset:15360
    buffer_load_dwordx4 v195, s[28:31], s67 offen offset:2048 lds
.p2align 3
    s_cmp_eq_u32 s96, 1
    s_cselect_b32 s100, s16, s18
    s_cselect_b32 s101, s18, s16
    s_sub_u32 s60, s17, s100
    v_add_u32_e32 v0, s100, v4
    v_add_u32_e32 v2, s101, v6
    v_add_u32_e32 v3, s101, v7
    v_mad_i32_i24 v0, v8, s60, v0
    v_add_u32_e32 v1, v0, v5
    v_pk_fma_f32 v[128:129], v[144:145], v[144:145], s[32:33]
    v_pk_fma_f32 v[130:131], v[146:147], v[146:147], s[32:33]
    v_pk_fma_f32 v[132:133], v[148:149], v[148:149], s[32:33]
    v_pk_fma_f32 v[134:135], v[150:151], v[150:151], s[32:33]
    v_pk_fma_f32 v[136:137], v[152:153], v[152:153], s[32:33]
    v_pk_fma_f32 v[138:139], v[154:155], v[154:155], s[32:33]
    v_pk_fma_f32 v[140:141], v[156:157], v[156:157], s[32:33]
    v_pk_fma_f32 v[142:143], v[158:159], v[158:159], s[32:33]
    v_pk_mul_f32 v[128:129], v[128:129], v[144:145] neg_lo:[1,0] neg_hi:[1,0]
    v_pk_mul_f32 v[130:131], v[130:131], v[146:147] neg_lo:[1,0] neg_hi:[1,0]
    v_pk_mul_f32 v[132:133], v[132:133], v[148:149] neg_lo:[1,0] neg_hi:[1,0]
    v_pk_mul_f32 v[134:135], v[134:135], v[150:151] neg_lo:[1,0] neg_hi:[1,0]
    v_pk_mul_f32 v[136:137], v[136:137], v[152:153] neg_lo:[1,0] neg_hi:[1,0]
    v_pk_mul_f32 v[138:139], v[138:139], v[154:155] neg_lo:[1,0] neg_hi:[1,0]
    v_pk_mul_f32 v[140:141], v[140:141], v[156:157] neg_lo:[1,0] neg_hi:[1,0]
    v_pk_mul_f32 v[142:143], v[142:143], v[158:159] neg_lo:[1,0] neg_hi:[1,0]
    v_mfma_f32_32x32x16_bf16 v[160:175], a[24:27], v[104:107], 0
    v_exp_f32_e32 v128, v128
    v_exp_f32_e32 v129, v129
    v_exp_f32_e32 v130, v130
    v_exp_f32_e32 v131, v131
    v_exp_f32_e32 v132, v132
    v_exp_f32_e32 v133, v133
    v_exp_f32_e32 v134, v134
    v_mfma_f32_32x32x16_bf16 v[160:175], a[28:31], v[108:111], v[160:175]
    v_exp_f32_e32 v135, v135
    v_exp_f32_e32 v136, v136
    v_exp_f32_e32 v137, v137
    v_exp_f32_e32 v138, v138
    v_exp_f32_e32 v139, v139
    v_exp_f32_e32 v140, v140
    v_exp_f32_e32 v141, v141
    v_exp_f32_e32 v142, v142
    v_exp_f32_e32 v143, v143
    v_pk_fma_f32 v[128:129], v[128:129], s[34:35], s[34:35]
    v_pk_fma_f32 v[130:131], v[130:131], s[34:35], s[34:35]
    v_pk_fma_f32 v[132:133], v[132:133], s[34:35], s[34:35]
    v_pk_fma_f32 v[134:135], v[134:135], s[34:35], s[34:35]
    v_pk_fma_f32 v[136:137], v[136:137], s[34:35], s[34:35]
    v_pk_fma_f32 v[138:139], v[138:139], s[34:35], s[34:35]
    v_pk_fma_f32 v[140:141], v[140:141], s[34:35], s[34:35]
    v_pk_fma_f32 v[142:143], v[142:143], s[34:35], s[34:35]
    v_mfma_f32_32x32x16_bf16 v[160:175], a[32:35], v[112:115], v[160:175]
    s_sub_u32 s59, s49, s99
    v_subrev_u32_e32 v78, 0xe480, v14
    v_rcp_f32_e32 v128, v128
    v_rcp_f32_e32 v129, v129
    v_rcp_f32_e32 v130, v130
    v_rcp_f32_e32 v131, v131
    v_rcp_f32_e32 v132, v132
    v_mfma_f32_32x32x16_bf16 v[160:175], a[36:39], v[116:119], v[160:175]
    s_cmp_lt_u32 s59, 2
    s_waitcnt vmcnt(6) lgkmcnt(0)
    s_barrier
    ds_read_b64_tr_b16 a[144:145], v22
    ds_read_b64_tr_b16 a[146:147], v22 offset:1536
    ds_read_b64_tr_b16 a[148:149], v23 offset:64
    ds_read_b64_tr_b16 a[150:151], v23 offset:1600
    v_rcp_f32_e32 v133, v133
    v_rcp_f32_e32 v134, v134
    v_rcp_f32_e32 v135, v135
    v_mfma_f32_32x32x16_bf16 v[160:175], a[40:43], v[120:123], v[160:175]
    s_cbranch_scc1 L_borderf
L_border_retf:
    ds_read_b64_tr_b16 a[152:153], v79 offset:128
    ds_read_b64_tr_b16 a[154:155], v79 offset:1664
    ds_read_b64_tr_b16 a[156:157], v22 offset:3072
    ds_read_b64_tr_b16 a[158:159], v22 offset:4608
    v_rcp_f32_e32 v136, v136
    v_rcp_f32_e32 v137, v137
    v_rcp_f32_e32 v138, v138
    v_mfma_f32_32x32x16_bf16 v[160:175], a[44:47], v[124:127], v[160:175]
    ds_read_b64_tr_b16 a[160:161], v23 offset:3136
    ds_read_b64_tr_b16 a[162:163], v23 offset:4672
    ds_read_b64_tr_b16 a[164:165], v79 offset:3200
    ds_read_b64_tr_b16 a[166:167], v79 offset:4736
    v_rcp_f32_e32 v139, v139
    v_rcp_f32_e32 v140, v140
    v_rcp_f32_e32 v141, v141
    v_rcp_f32_e32 v142, v142
    v_rcp_f32_e64 v143, v143
    v_pk_mul_f32 v[144:145], v[144:145], v[128:129]
    v_pk_mul_f32 v[146:147], v[146:147], v[130:131]
    v_pk_mul_f32 v[148:149], v[148:149], v[132:133]
    v_pk_mul_f32 v[150:151], v[150:151], v[134:135]
    v_pk_mul_f32 v[152:153], v[152:153], v[136:137]
    v_pk_mul_f32 v[154:155], v[154:155], v[138:139]
    v_pk_mul_f32 v[156:157], v[156:157], v[140:141]
    v_pk_mul_f32 v[158:159], v[158:159], v[142:143]
    v_pk_fma_f32 v[128:129], v[160:161], v[160:161], s[32:33]
    v_pk_fma_f32 v[130:131], v[162:163], v[162:163], s[32:33]
    v_pk_fma_f32 v[132:133], v[164:165], v[164:165], s[32:33]
    v_pk_fma_f32 v[134:135], v[166:167], v[166:167], s[32:33]
    v_pk_fma_f32 v[136:137], v[168:169], v[168:169], s[32:33]
    v_pk_fma_f32 v[138:139], v[170:171], v[170:171], s[32:33]
    v_pk_fma_f32 v[140:141], v[172:173], v[172:173], s[32:33]
    v_pk_fma_f32 v[142:143], v[174:175], v[174:175], s[32:33]
    v_pk_mul_f32 v[128:129], v[128:129], v[160:161] neg_lo:[1,0] neg_hi:[1,0]
    v_pk_mul_f32 v[130:131], v[130:131], v[162:163] neg_lo:[1,0] neg_hi:[1,0]
    v_pk_mul_f32 v[132:133], v[132:133], v[164:165] neg_lo:[1,0] neg_hi:[1,0]
    v_pk_mul_f32 v[134:135], v[134:135], v[166:167] neg_lo:[1,0] neg_hi:[1,0]
    v_pk_mul_f32 v[136:137], v[136:137], v[168:169] neg_lo:[1,0] neg_hi:[1,0]
    v_pk_mul_f32 v[138:139], v[138:139], v[170:171] neg_lo:[1,0] neg_hi:[1,0]
    v_pk_mul_f32 v[140:141], v[140:141], v[172:173] neg_lo:[1,0] neg_hi:[1,0]
    v_pk_mul_f32 v[142:143], v[142:143], v[174:175] neg_lo:[1,0] neg_hi:[1,0]
    v_cvt_pk_bf16_f32 v144, v144, v145
    v_cvt_pk_bf16_f32 v145, v146, v147
    v_cvt_pk_bf16_f32 v146, v148, v149
    v_cvt_pk_bf16_f32 v147, v150, v151
    v_cvt_pk_bf16_f32 v148, v152, v153
    v_cvt_pk_bf16_f32 v149, v154, v155
    s_waitcnt lgkmcnt(6)
    v_mfma_f32_32x32x16_bf16 v[208:223], a[152:155], v[144:147], 0
    s_waitcnt lgkmcnt(0)
    s_waitcnt vmcnt(0)
    s_barrier
    ds_read2_b64 v[44:47], v0 offset0:0 offset1:24
    ds_read2_b64 v[48:51], v1 offset0:0 offset1:24
    ds_read2_b64 v[68:71], v3 offset0:0 offset1:1
    v_cvt_pk_bf16_f32 v150, v156, v157
    v_cvt_pk_bf16_f32 v151, v158, v159
    v_mfma_f32_32x32x16_bf16 v[192:207], a[148:151], v[144:147], 0
    ds_read_b64_tr_b16 a[168:169], v22 offset:12288
    ds_read_b64_tr_b16 a[170:171], v22 offset:13824
    ds_read_b64_tr_b16 a[172:173], v23 offset:12352
    ds_read_b64_tr_b16 a[174:175], v23 offset:13888
    s_add_u32 s67, s41, 0x4800
    s_add_u32 m0, s42, 0x1e480
    s_nop 0
    buffer_load_dwordx4 v78, s[28:31], s67 offen lds
    ds_read2_b64 v[56:59], v0 offset0:50 offset1:74
    ds_read2_b64 v[60:63], v2 offset0:0 offset1:24
    v_exp_f32_e32 v128, v128
    v_mfma_f32_32x32x16_bf16 v[176:191], a[144:147], v[144:147], 0
    ds_read_b64_tr_b16 a[176:177], v79 offset:12416
    ds_read_b64_tr_b16 a[178:179], v79 offset:13952
    ds_read_b64_tr_b16 a[180:181], v22 offset:15360
    ds_read_b64_tr_b16 a[182:183], v22 offset:16896
    buffer_load_dwordx4 v78, s[28:31], s67 offen offset:1024 lds
    v_exp_f32_e32 v129, v129
    v_exp_f32_e32 v130, v130
    v_mfma_f32_32x32x16_bf16 v[208:223], a[164:167], v[148:151], v[208:223]
    ds_write_b128 v9, a[216:219]
    v_exp_f32_e32 v131, v131
    v_exp_f32_e32 v132, v132
    s_waitcnt lgkmcnt(11)
    v_mfma_f32_16x16x16_bf16 v[80:83], v[32:33], v[68:69], 0
    v_exp_f32_e32 v133, v133
    v_exp_f32_e32 v134, v134
    v_exp_f32_e32 v135, v135
    v_mfma_f32_16x16x16_bf16 v[84:87], v[34:35], v[70:71], 0
    v_exp_f32_e32 v136, v136
    v_exp_f32_e32 v137, v137
    v_exp_f32_e32 v138, v138
    v_exp_f32_e32 v139, v139
    v_mfma_f32_32x32x16_bf16 v[192:207], a[160:163], v[148:151], v[192:207]
    s_waitcnt lgkmcnt(1)
    ds_read_b64_tr_b16 a[184:185], v23 offset:15424
    ds_read_b64_tr_b16 a[186:187], v23 offset:16960
    ds_read_b64_tr_b16 a[188:189], v79 offset:15488
    ds_read_b64_tr_b16 a[190:191], v79 offset:17024
    buffer_load_dwordx4 v78, s[28:31], s67 offen offset:2048 lds
    ds_read2_b64 v[68:71], v3 offset0:2 offset1:3
    v_exp_f32_e32 v140, v140
    v_smfmac_f32_16x16x64_bf16 v[80:83], a[216:219], v[44:51], v15
    ds_read2_b64 v[44:47], v0 offset0:1 offset1:25
    ds_read2_b64 v[48:51], v1 offset0:1 offset1:25
    v_exp_f32_e32 v141, v141
    v_mfma_f32_32x32x16_bf16 v[176:191], a[156:159], v[148:151], v[176:191]
    s_waitcnt lgkmcnt(7)
    s_add_u32 m0, s40, s19
    s_nop 0
    buffer_load_dwordx4 v64, s[24:27], s47 offen nt lds
    ds_write_b128 v9, a[220:223] offset:1024
    v_exp_f32_e32 v142, v142
    v_exp_f32_e32 v143, v143
    v_pk_fma_f32 v[128:129], v[128:129], s[34:35], s[34:35]
    v_pk_fma_f32 v[130:131], v[130:131], s[34:35], s[34:35]
    v_pk_fma_f32 v[132:133], v[132:133], s[34:35], s[34:35]
    v_pk_fma_f32 v[134:135], v[134:135], s[34:35], s[34:35]
    v_pk_fma_f32 v[136:137], v[136:137], s[34:35], s[34:35]
    v_pk_fma_f32 v[138:139], v[138:139], s[34:35], s[34:35]
    v_pk_fma_f32 v[140:141], v[140:141], s[34:35], s[34:35]
    v_pk_fma_f32 v[142:143], v[142:143], s[34:35], s[34:35]
    v_mfma_f32_32x32x16_bf16 v[144:159], a[48:51], v[104:107], 0
    s_waitcnt lgkmcnt(4)
    ds_read_b64_tr_b16 a[192:193], v22 offset:24576
    ds_read_b64_tr_b16 a[194:195], v22 offset:26112
    ds_read_b64_tr_b16 a[196:197], v23 offset:24640
    ds_read_b64_tr_b16 a[198:199], v23 offset:26176
    buffer_load_dwordx4 v17, s[24:27], s47 offen offset:1024 nt lds
    v_rcp_f32_e32 v128, v128
    v_smfmac_f32_16x16x64_bf16 v[80:83], a[220:223], v[56:63], v15
    ds_read2_b64 v[56:59], v0 offset0:51 offset1:75
    ds_read2_b64 v[60:63], v2 offset0:1 offset1:25
    v_rcp_f32_e32 v129, v129
    v_mfma_f32_32x32x16_bf16 v[144:159], a[52:55], v[108:111], v[144:159]
    s_waitcnt lgkmcnt(6)
    ds_write_b128 v9, a[224:227] offset:2048
    v_rcp_f32_e32 v130, v130
    v_mfma_f32_16x16x16_bf16 v[88:91], v[36:37], v[68:69], 0
    v_rcp_f32_e32 v131, v131
    v_rcp_f32_e32 v132, v132
    v_mfma_f32_16x16x16_bf16 v[92:95], v[38:39], v[70:71], 0
    v_rcp_f32_e32 v133, v133
    v_rcp_f32_e32 v134, v134
    v_rcp_f32_e32 v135, v135
    v_mfma_f32_32x32x16_bf16 v[144:159], a[56:59], v[112:115], v[144:159]
    s_waitcnt lgkmcnt(3)
    ds_read_b64_tr_b16 a[200:201], v79 offset:24704
    ds_read_b64_tr_b16 a[202:203], v79 offset:26240
    ds_read_b64_tr_b16 a[204:205], v22 offset:27648
    ds_read_b64_tr_b16 a[206:207], v22 offset:29184
    buffer_load_dwordx4 v18, s[24:27], s47 offen offset:2048 nt lds
    ds_read2_b64 v[68:71], v3 offset0:4 offset1:5
    v_rcp_f32_e32 v136, v136
    v_smfmac_f32_16x16x64_bf16 v[84:87], a[224:227], v[44:51], v15
    ds_read2_b64 v[44:47], v0 offset0:2 offset1:26
    ds_read2_b64 v[48:51], v1 offset0:2 offset1:26
    v_rcp_f32_e32 v137, v137
    v_mfma_f32_32x32x16_bf16 v[144:159], a[60:63], v[116:119], v[144:159]
    s_waitcnt lgkmcnt(7)
    ds_write_b128 v9, a[228:231] offset:3072
    v_rcp_f32_e32 v138, v138
    v_mfma_f32_32x32x16_bf16 v[144:159], a[64:67], v[120:123], v[144:159]
    ds_read_b64_tr_b16 a[208:209], v23 offset:27712
    ds_read_b64_tr_b16 a[210:211], v23 offset:29248
    ds_read_b64_tr_b16 a[212:213], v79 offset:27776
    ds_read_b64_tr_b16 a[214:215], v79 offset:29312
    s_mov_b32 exec_hi, 0
    buffer_load_dwordx4 v65, s[24:27], s47 offen offset:3072 nt lds
    s_mov_b32 exec_hi, -1
    v_rcp_f32_e32 v139, v139
    v_smfmac_f32_16x16x64_bf16 v[84:87], a[228:231], v[56:63], v15
    ds_read2_b64 v[56:59], v0 offset0:52 offset1:76
    ds_read2_b64 v[60:63], v2 offset0:2 offset1:26
    v_rcp_f32_e32 v140, v140
    v_mfma_f32_32x32x16_bf16 v[144:159], a[68:71], v[124:127], v[144:159]
    s_waitcnt lgkmcnt(9)
    ds_write_b128 v9, a[232:235] offset:4096
    v_rcp_f32_e32 v141, v141
    v_rcp_f32_e32 v142, v142
    v_rcp_f32_e64 v143, v143
    v_pk_mul_f32 v[160:161], v[160:161], v[128:129]
    v_pk_mul_f32 v[162:163], v[162:163], v[130:131]
    v_pk_mul_f32 v[164:165], v[164:165], v[132:133]
    v_pk_mul_f32 v[166:167], v[166:167], v[134:135]
    v_pk_mul_f32 v[168:169], v[168:169], v[136:137]
    v_pk_mul_f32 v[170:171], v[170:171], v[138:139]
    v_pk_mul_f32 v[172:173], v[172:173], v[140:141]
    v_pk_mul_f32 v[174:175], v[174:175], v[142:143]
    v_pk_add_f32 v[72:73], v[80:81], v[82:83]
    v_pk_mul_f32 v[74:75], v[80:81], v[80:81]
    v_pk_fma_f32 v[74:75], v[82:83], v[82:83], v[74:75]
    v_pk_fma_f32 v[128:129], v[144:145], v[144:145], s[32:33]
    v_pk_fma_f32 v[130:131], v[146:147], v[146:147], s[32:33]
    v_pk_fma_f32 v[132:133], v[148:149], v[148:149], s[32:33]
    v_pk_fma_f32 v[134:135], v[150:151], v[150:151], s[32:33]
    v_pk_fma_f32 v[136:137], v[152:153], v[152:153], s[32:33]
    v_pk_fma_f32 v[138:139], v[154:155], v[154:155], s[32:33]
    v_pk_fma_f32 v[140:141], v[156:157], v[156:157], s[32:33]
    v_pk_fma_f32 v[142:143], v[158:159], v[158:159], s[32:33]
    v_pk_mul_f32 v[128:129], v[128:129], v[144:145] neg_lo:[1,0] neg_hi:[1,0]
    v_pk_mul_f32 v[130:131], v[130:131], v[146:147] neg_lo:[1,0] neg_hi:[1,0]
    v_pk_mul_f32 v[132:133], v[132:133], v[148:149] neg_lo:[1,0] neg_hi:[1,0]
    v_pk_mul_f32 v[134:135], v[134:135], v[150:151] neg_lo:[1,0] neg_hi:[1,0]
    v_pk_mul_f32 v[136:137], v[136:137], v[152:153] neg_lo:[1,0] neg_hi:[1,0]
    v_pk_mul_f32 v[138:139], v[138:139], v[154:155] neg_lo:[1,0] neg_hi:[1,0]
    v_pk_mul_f32 v[140:141], v[140:141], v[156:157] neg_lo:[1,0] neg_hi:[1,0]
    v_pk_mul_f32 v[142:143], v[142:143], v[158:159] neg_lo:[1,0] neg_hi:[1,0]
    v_mfma_f32_16x16x16_bf16 v[96:99], v[40:41], v[68:69], 0
    v_cvt_pk_bf16_f32 v160, v160, v161
    v_cvt_pk_bf16_f32 v161, v162, v163
    v_cvt_pk_bf16_f32 v162, v164, v165
    v_cvt_pk_bf16_f32 v163, v166, v167
    v_mfma_f32_16x16x16_bf16 v[100:103], v[42:43], v[70:71], 0
    v_cvt_pk_bf16_f32 v164, v168, v169
    v_cvt_pk_bf16_f32 v165, v170, v171
    v_cvt_pk_bf16_f32 v166, v172, v173
    v_cvt_pk_bf16_f32 v167, v174, v175
    v_exp_f32_e32 v128, v128
    v_mfma_f32_32x32x16_bf16 v[208:223], a[176:179], v[160:163], v[208:223]
    s_waitcnt lgkmcnt(0)
    s_waitcnt vmcnt(4)
    s_barrier
    v_exp_f32_e32 v129, v129
    v_exp_f32_e32 v130, v130
    v_smfmac_f32_16x16x64_bf16 v[88:91], a[232:235], v[44:51], v15
    ds_read2_b64 v[44:47], v0 offset0:3 offset1:27
    ds_read2_b64 v[48:51], v1 offset0:3 offset1:27
    v_exp_f32_e32 v131, v131
    v_mfma_f32_32x32x16_bf16 v[192:207], a[172:175], v[160:163], v[192:207]
    s_add_u32 s67, s41, 0x6000
    s_add_u32 m0, s42, 0x21480
    s_nop 0
    buffer_load_dwordx4 v78, s[28:31], s67 offen lds
    v_exp_f32_e32 v132, v132
    v_exp_f32_e32 v133, v133
    v_smfmac_f32_16x16x64_bf16 v[88:91], a[236:239], v[56:63], v15
    ds_read2_b64 v[56:59], v0 offset0:53 offset1:77
    ds_read2_b64 v[60:63], v2 offset0:3 offset1:27
    v_mfma_f32_32x32x16_bf16 v[176:191], a[168:171], v[160:163], v[176:191]
    ds_write_b128 v9, a[236:239] offset:5120
    v_exp_f32_e32 v134, v134
    v_mfma_f32_32x32x16_bf16 v[208:223], a[188:191], v[164:167], v[208:223]
    buffer_load_dwordx4 v78, s[28:31], s67 offen offset:1024 lds
    v_exp_f32_e32 v135, v135
    v_exp_f32_e32 v136, v136
    v_exp_f32_e32 v137, v137
    v_mfma_f32_32x32x16_bf16 v[192:207], a[184:187], v[164:167], v[192:207]
    s_waitcnt lgkmcnt(3)
    buffer_load_dwordx4 v78, s[28:31], s67 offen offset:2048 lds
    v_exp_f32_e32 v138, v138
    v_exp_f32_e32 v139, v139
    v_exp_f32_e32 v140, v140
    v_smfmac_f32_16x16x64_bf16 v[92:95], a[240:243], v[44:51], v15
    ds_read2_b64 v[44:47], v0 offset0:4 offset1:28
    ds_read2_b64 v[48:51], v1 offset0:4 offset1:28
    v_exp_f32_e32 v141, v141
    v_mfma_f32_32x32x16_bf16 v[176:191], a[180:183], v[164:167], v[176:191]
    s_waitcnt lgkmcnt(2)
    ds_write_b128 v9, a[240:243] offset:6144
    v_exp_f32_e32 v142, v142
    v_exp_f32_e32 v143, v143
    v_pk_fma_f32 v[128:129], v[128:129], s[34:35], s[34:35]
    v_pk_fma_f32 v[130:131], v[130:131], s[34:35], s[34:35]
    v_pk_fma_f32 v[132:133], v[132:133], s[34:35], s[34:35]
    v_pk_fma_f32 v[134:135], v[134:135], s[34:35], s[34:35]
    v_pk_fma_f32 v[136:137], v[136:137], s[34:35], s[34:35]
    v_pk_fma_f32 v[138:139], v[138:139], s[34:35], s[34:35]
    v_pk_fma_f32 v[140:141], v[140:141], s[34:35], s[34:35]
    v_pk_fma_f32 v[142:143], v[142:143], s[34:35], s[34:35]
    v_pk_add_f32 v[72:73], v[72:73], v[84:85]
    v_pk_fma_f32 v[74:75], v[84:85], v[84:85], v[74:75]
    v_pk_add_f32 v[72:73], v[72:73], v[86:87]
    v_pk_fma_f32 v[74:75], v[86:87], v[86:87], v[74:75]
    v_pk_add_f32 v[72:73], v[72:73], v[88:89]
    v_pk_fma_f32 v[74:75], v[88:89], v[88:89], v[74:75]
    v_pk_add_f32 v[72:73], v[72:73], v[90:91]
    v_pk_fma_f32 v[74:75], v[90:91], v[90:91], v[74:75]
    v_mfma_f32_32x32x16_bf16 v[160:175], a[72:75], v[104:107], 0
    s_waitcnt lgkmcnt(2)
    ds_read_b64_tr_b16 a[216:217], v22
    ds_read_b64_tr_b16 a[218:219], v22 offset:1536
    ds_read_b64_tr_b16 a[220:221], v23 offset:64
    ds_read_b64_tr_b16 a[222:223], v23 offset:1600
    s_add_u32 s67, s41, 0x7800
    s_add_u32 m0, s42, 0x24480
    s_nop 0
    buffer_load_dwordx4 v78, s[28:31], s67 offen lds
    v_rcp_f32_e32 v128, v128
    v_smfmac_f32_16x16x64_bf16 v[92:95], a[244:247], v[56:63], v15
    ds_read2_b64 v[56:59], v0 offset0:54 offset1:78
    ds_read2_b64 v[60:63], v2 offset0:4 offset1:28
    v_rcp_f32_e32 v129, v129
    v_mfma_f32_32x32x16_bf16 v[160:175], a[76:79], v[108:111], v[160:175]
    s_waitcnt lgkmcnt(6)
    ds_write_b128 v9, a[244:247] offset:7168
    v_rcp_f32_e32 v130, v130
    v_rcp_f32_e32 v131, v131
    v_mfma_f32_32x32x16_bf16 v[160:175], a[80:83], v[112:115], v[160:175]
    ds_read_b64_tr_b16 a[224:225], v79 offset:128
    ds_read_b64_tr_b16 a[226:227], v79 offset:1664
    ds_read_b64_tr_b16 a[228:229], v22 offset:3072
    ds_read_b64_tr_b16 a[230:231], v22 offset:4608
    buffer_load_dwordx4 v78, s[28:31], s67 offen offset:1024 lds
    v_rcp_f32_e32 v132, v132
    v_rcp_f32_e32 v133, v133
    v_smfmac_f32_16x16x64_bf16 v[96:99], a[248:251], v[44:51], v15
    ds_read2_b64 v[44:47], v0 offset0:5 offset1:29
    ds_read2_b64 v[48:51], v1 offset0:5 offset1:29
    v_rcp_f32_e32 v134, v134
    v_mfma_f32_32x32x16_bf16 v[160:175], a[84:87], v[116:119], v[160:175]
    s_waitcnt lgkmcnt(7)
    ds_write_b128 v9, a[248:251] offset:8192
    v_rcp_f32_e32 v135, v135
    v_rcp_f32_e32 v136, v136
    v_mfma_f32_32x32x16_bf16 v[160:175], a[88:91], v[120:123], v[160:175]
    s_waitcnt lgkmcnt(7)
    ds_read_b64_tr_b16 a[232:233], v23 offset:3136
    ds_read_b64_tr_b16 a[234:235], v23 offset:4672
    ds_read_b64_tr_b16 a[236:237], v79 offset:3200
    ds_read_b64_tr_b16 a[238:239], v79 offset:4736
    buffer_load_dwordx4 v78, s[28:31], s67 offen offset:2048 lds
    v_rcp_f32_e32 v137, v137
    v_rcp_f32_e32 v138, v138
    v_smfmac_f32_16x16x64_bf16 v[96:99], a[252:255], v[56:63], v15
    ds_read2_b64 v[56:59], v0 offset0:55 offset1:79
    ds_read2_b64 v[60:63], v2 offset0:5 offset1:29
    v_rcp_f32_e32 v139, v139
    v_rcp_f32_e32 v140, v140
    v_mfma_f32_32x32x16_bf16 v[160:175], a[92:95], v[124:127], v[160:175]
    s_waitcnt lgkmcnt(7)
    ds_write_b128 v9, a[252:255] offset:9216
    v_rcp_f32_e32 v141, v141
    v_rcp_f32_e32 v142, v142
    v_rcp_f32_e32 v143, v143
    v_pk_mul_f32 v[144:145], v[144:145], v[128:129]
    v_pk_mul_f32 v[146:147], v[146:147], v[130:131]
    v_pk_mul_f32 v[148:149], v[148:149], v[132:133]
    v_pk_mul_f32 v[150:151], v[150:151], v[134:135]
    v_pk_mul_f32 v[152:153], v[152:153], v[136:137]
    v_pk_mul_f32 v[154:155], v[154:155], v[138:139]
    v_pk_mul_f32 v[156:157], v[156:157], v[140:141]
    v_pk_mul_f32 v[158:159], v[158:159], v[142:143]
    v_pk_add_f32 v[72:73], v[72:73], v[92:93]
    v_pk_fma_f32 v[74:75], v[92:93], v[92:93], v[74:75]
    v_pk_add_f32 v[72:73], v[72:73], v[94:95]
    v_pk_fma_f32 v[74:75], v[94:95], v[94:95], v[74:75]
    v_pk_fma_f32 v[128:129], v[160:161], v[160:161], s[32:33]
    v_pk_fma_f32 v[130:131], v[162:163], v[162:163], s[32:33]
    v_pk_fma_f32 v[132:133], v[164:165], v[164:165], s[32:33]
    v_pk_fma_f32 v[134:135], v[166:167], v[166:167], s[32:33]
    v_pk_fma_f32 v[136:137], v[168:169], v[168:169], s[32:33]
    v_pk_fma_f32 v[138:139], v[170:171], v[170:171], s[32:33]
    v_pk_fma_f32 v[140:141], v[172:173], v[172:173], s[32:33]
    v_pk_fma_f32 v[142:143], v[174:175], v[174:175], s[32:33]
    v_pk_mul_f32 v[128:129], v[128:129], v[160:161] neg_lo:[1,0] neg_hi:[1,0]
    v_pk_mul_f32 v[130:131], v[130:131], v[162:163] neg_lo:[1,0] neg_hi:[1,0]
    v_pk_mul_f32 v[132:133], v[132:133], v[164:165] neg_lo:[1,0] neg_hi:[1,0]
    v_pk_mul_f32 v[134:135], v[134:135], v[166:167] neg_lo:[1,0] neg_hi:[1,0]
    v_pk_mul_f32 v[136:137], v[136:137], v[168:169] neg_lo:[1,0] neg_hi:[1,0]
    v_pk_mul_f32 v[138:139], v[138:139], v[170:171] neg_lo:[1,0] neg_hi:[1,0]
    v_pk_mul_f32 v[140:141], v[140:141], v[172:173] neg_lo:[1,0] neg_hi:[1,0]
    v_pk_mul_f32 v[142:143], v[142:143], v[174:175] neg_lo:[1,0] neg_hi:[1,0]
    v_pk_add_f32 v[72:73], v[72:73], v[96:97]
    v_pk_fma_f32 v[74:75], v[96:97], v[96:97], v[74:75]
    v_pk_add_f32 v[72:73], v[72:73], v[98:99]
    v_pk_fma_f32 v[74:75], v[98:99], v[98:99], v[74:75]
    s_waitcnt lgkmcnt(0)
    v_cvt_pk_bf16_f32 v144, v144, v145
    v_cvt_pk_bf16_f32 v145, v146, v147
    v_cvt_pk_bf16_f32 v146, v148, v149
    v_add_u32_e32 v78, s16, v21
    v_smfmac_f32_16x16x64_bf16 v[100:103], v[224:227], v[44:51], v15
    v_cvt_pk_bf16_f32 v147, v150, v151
    v_cvt_pk_bf16_f32 v148, v152, v153
    v_smfmac_f32_16x16x64_bf16 v[100:103], v[228:231], v[56:63], v15
    v_cvt_pk_bf16_f32 v149, v154, v155
    v_cvt_pk_bf16_f32 v150, v156, v157
    v_mfma_f32_32x32x16_bf16 v[208:223], a[200:203], v[144:147], v[208:223]
    ds_read2_b64 v[64:67], v78 offset0:8 offset1:9
    ds_read2_b64 v[56:59], v78 offset0:0 offset1:1
    ds_read2_b64 v[60:63], v78 offset0:4 offset1:5
    v_cvt_pk_bf16_f32 v151, v158, v159
    v_exp_f32_e32 v128, v128
    v_exp_f32_e32 v129, v129
    v_mfma_f32_32x32x16_bf16 v[192:207], a[196:199], v[144:147], v[192:207]
    s_mov_b32 s43, s44
    ds_write_b128 v9, v[224:227] offset:10240
    v_exp_f32_e32 v130, v130
    v_mfma_f32_32x32x16_bf16 v[176:191], a[192:195], v[144:147], v[176:191]
    s_mov_b32 s44, s45
    v_exp_f32_e32 v131, v131
    v_exp_f32_e32 v132, v132
    v_exp_f32_e32 v133, v133
    v_exp_f32_e32 v134, v134
    v_mfma_f32_32x32x16_bf16 v[208:223], a[212:215], v[148:151], v[208:223]
    s_mov_b32 s45, s46
    ds_write_b128 v9, v[228:231] offset:11264
    v_exp_f32_e32 v135, v135
    v_mfma_f32_32x32x16_bf16 v[192:207], a[208:211], v[148:151], v[192:207]
    s_mov_b32 s46, s47
    v_exp_f32_e32 v136, v136
    v_exp_f32_e32 v137, v137
    v_exp_f32_e32 v138, v138
    v_mfma_f32_32x32x16_bf16 v[176:191], a[204:207], v[148:151], v[176:191]
    s_mov_b32 s47, s48
    v_exp_f32_e32 v139, v139
    v_exp_f32_e32 v140, v140
    v_exp_f32_e32 v141, v141
    v_exp_f32_e32 v142, v142
    v_exp_f32_e64 v143, v143
    v_pk_fma_f32 v[128:129], v[128:129], s[34:35], s[34:35]
    v_pk_fma_f32 v[130:131], v[130:131], s[34:35], s[34:35]
    v_pk_fma_f32 v[132:133], v[132:133], s[34:35], s[34:35]
    v_pk_fma_f32 v[134:135], v[134:135], s[34:35], s[34:35]
    v_pk_fma_f32 v[136:137], v[136:137], s[34:35], s[34:35]
    v_pk_fma_f32 v[138:139], v[138:139], s[34:35], s[34:35]
    v_pk_fma_f32 v[140:141], v[140:141], s[34:35], s[34:35]
    v_pk_fma_f32 v[142:143], v[142:143], s[34:35], s[34:35]
    v_pk_add_f32 v[72:73], v[72:73], v[100:101]
    v_pk_fma_f32 v[74:75], v[100:101], v[100:101], v[74:75]
    v_pk_add_f32 v[72:73], v[72:73], v[102:103]
    v_pk_fma_f32 v[74:75], v[102:103], v[102:103], v[74:75]
    v_add_f32_e32 v72, v72, v73
    v_add_f32_e32 v73, v74, v75
    v_mfma_f32_32x32x16_bf16 v[144:159], a[96:99], v[104:107], 0
    s_cmp_eq_u32 s50, 0
    ds_write_b64 v13, v[72:73] offset:3072
    v_rcp_f32_e32 v128, v128
    v_rcp_f32_e32 v129, v129
    v_mfma_f32_32x32x16_bf16 v[144:159], a[100:103], v[108:111], v[144:159]
    s_cselect_b64 s[56:57], s[52:53], 0
    v_rcp_f32_e32 v130, v130
    v_rcp_f32_e32 v131, v131
    v_rcp_f32_e32 v132, v132
    v_mfma_f32_32x32x16_bf16 v[144:159], a[104:107], v[112:115], v[144:159]
    s_cmp_eq_u32 s50, 11
    v_rcp_f32_e32 v133, v133
    v_rcp_f32_e32 v134, v134
    v_rcp_f32_e32 v135, v135
    v_mfma_f32_32x32x16_bf16 v[144:159], a[108:111], v[116:119], v[144:159]
    s_cselect_b64 s[38:39], s[54:55], 0
    v_rcp_f32_e32 v136, v136
    v_rcp_f32_e32 v137, v137
    v_rcp_f32_e32 v138, v138
    v_mfma_f32_32x32x16_bf16 v[144:159], a[112:115], v[120:123], v[144:159]
    v_rcp_f32_e32 v139, v139
    v_rcp_f32_e32 v140, v140
    v_rcp_f32_e32 v141, v141
    v_mfma_f32_32x32x16_bf16 v[144:159], a[116:119], v[124:127], v[144:159]
    s_waitcnt lgkmcnt(0)
    s_waitcnt vmcnt(0)
    s_barrier
    ds_read_b64_tr_b16 a[240:241], v22 offset:12288
    ds_read_b64_tr_b16 a[242:243], v22 offset:13824
    ds_read_b64_tr_b16 a[244:245], v23 offset:12352
    v_rcp_f32_e32 v142, v142
    v_rcp_f32_e64 v143, v143
    v_pk_mul_f32 v[160:161], v[160:161], v[128:129]
    v_pk_mul_f32 v[162:163], v[162:163], v[130:131]
    v_pk_mul_f32 v[164:165], v[164:165], v[132:133]
    v_pk_mul_f32 v[166:167], v[166:167], v[134:135]
    v_pk_mul_f32 v[168:169], v[168:169], v[136:137]
    v_pk_mul_f32 v[170:171], v[170:171], v[138:139]
    v_pk_mul_f32 v[172:173], v[172:173], v[140:141]
    v_pk_mul_f32 v[174:175], v[174:175], v[142:143]
    v_pk_fma_f32 v[128:129], v[144:145], v[144:145], s[32:33]
    v_pk_fma_f32 v[130:131], v[146:147], v[146:147], s[32:33]
    v_pk_fma_f32 v[132:133], v[148:149], v[148:149], s[32:33]
    v_pk_fma_f32 v[134:135], v[150:151], v[150:151], s[32:33]
    v_pk_fma_f32 v[136:137], v[152:153], v[152:153], s[32:33]
    v_pk_fma_f32 v[138:139], v[154:155], v[154:155], s[32:33]
    v_pk_fma_f32 v[140:141], v[156:157], v[156:157], s[32:33]
    v_pk_fma_f32 v[142:143], v[158:159], v[158:159], s[32:33]
    v_pk_mul_f32 v[128:129], v[128:129], v[144:145] neg_lo:[1,0] neg_hi:[1,0]
    v_pk_mul_f32 v[130:131], v[130:131], v[146:147] neg_lo:[1,0] neg_hi:[1,0]
    v_pk_mul_f32 v[132:133], v[132:133], v[148:149] neg_lo:[1,0] neg_hi:[1,0]
    v_pk_mul_f32 v[134:135], v[134:135], v[150:151] neg_lo:[1,0] neg_hi:[1,0]
    v_pk_mul_f32 v[136:137], v[136:137], v[152:153] neg_lo:[1,0] neg_hi:[1,0]
    v_pk_mul_f32 v[138:139], v[138:139], v[154:155] neg_lo:[1,0] neg_hi:[1,0]
    v_pk_mul_f32 v[140:141], v[140:141], v[156:157] neg_lo:[1,0] neg_hi:[1,0]
    v_pk_mul_f32 v[142:143], v[142:143], v[158:159] neg_lo:[1,0] neg_hi:[1,0]
    v_mfma_f32_32x32x16_bf16 v[192:207], v[24:27], v[64:67], v[192:207]
    s_add_u32 s49, s49, s96
    ds_read2st64_b64 v[44:47], v14 offset0:6 offset1:14
    ds_read2st64_b64 v[48:51], v14 offset0:22 offset1:30
    v_cvt_pk_bf16_f32 v160, v160, v161
    v_cvt_pk_bf16_f32 v161, v162, v163
    v_cvt_pk_bf16_f32 v162, v164, v165
    v_cvt_pk_bf16_f32 v163, v166, v167
    v_cvt_pk_bf16_f32 v164, v168, v169
    v_cvt_pk_bf16_f32 v165, v170, v171
    v_cvt_pk_bf16_f32 v166, v172, v173
    v_cvt_pk_bf16_f32 v167, v174, v175
    v_mfma_f32_32x32x16_bf16 v[208:223], a[224:227], v[160:163], v[208:223]
    s_cmp_eq_u32 s49, s97
    ds_read_b64_tr_b16 a[246:247], v23 offset:13888
    ds_read_b64_tr_b16 a[248:249], v79 offset:12416
    ds_read_b64_tr_b16 a[250:251], v79 offset:13952
    v_exp_f32_e32 v128, v128
    v_exp_f32_e32 v129, v129
    v_exp_f32_e32 v130, v130
    v_mfma_f32_32x32x16_bf16 v[192:207], a[220:223], v[160:163], v[192:207]
    s_cselect_b32 s60, s61, s62
    ds_read_b64_tr_b16 a[252:253], v22 offset:15360
    ds_read_b64_tr_b16 a[254:255], v22 offset:16896
    ds_read_b64_tr_b16 v[224:225], v23 offset:15424
    v_exp_f32_e32 v131, v131
    v_exp_f32_e32 v132, v132
    v_exp_f32_e32 v133, v133
    v_exp_f32_e32 v134, v134
    v_mfma_f32_32x32x16_bf16 v[176:191], a[216:219], v[160:163], v[176:191]
    s_cselect_b32 s49, s98, s49
    s_waitcnt lgkmcnt(6)
    ds_read_b64_tr_b16 v[226:227], v23 offset:16960
    ds_read_b64_tr_b16 v[228:229], v79 offset:15488
    ds_read_b64_tr_b16 v[230:231], v79 offset:17024
    v_exp_f32_e32 v135, v135
    v_exp_f32_e32 v136, v136
    v_exp_f32_e32 v137, v137
    v_mfma_f32_32x32x16_bf16 v[208:223], a[236:239], v[164:167], v[208:223]
    s_cselect_b32 s100, s96, 0
    ds_read_b64_tr_b16 v[232:233], v22 offset:24576
    ds_read_b64_tr_b16 v[234:235], v22 offset:26112
    ds_read_b64_tr_b16 v[236:237], v23 offset:24640
    v_exp_f32_e32 v138, v138
    v_exp_f32_e32 v139, v139
    v_exp_f32_e32 v140, v140
    v_exp_f32_e32 v141, v141
    v_mfma_f32_32x32x16_bf16 v[192:207], a[232:235], v[164:167], v[192:207]
    s_add_u32 s50, s50, s100
    ds_read_b64_tr_b16 v[238:239], v23 offset:26176
    ds_read_b64_tr_b16 v[240:241], v79 offset:24704
    ds_read_b64_tr_b16 v[242:243], v79 offset:26240
    v_exp_f32_e32 v142, v142
    v_add_f32_e32 v72, v44, v46
    v_add_f32_e32 v73, v45, v47
    v_add_f32_e32 v74, v48, v50
    v_add_f32_e32 v75, v49, v51
    v_add_f32_e32 v72, v72, v74
    v_mfma_f32_32x32x16_bf16 v[176:191], a[228:231], v[164:167], v[176:191]
    s_add_u32 s48, s48, s60
    v_add_f32_e32 v73, v73, v75
    v_mul_f32_e32 v74, s36, v72
    v_mul_f32_e32 v73, s37, v73
    v_fma_f32 v73, -v74, v74, v73
    v_max_f32_e32 v73, 0, v73
    v_add_f32_e32 v73, s63, v73
    v_mul_f32_e32 v74, s34, v74
    v_rsq_f32_e32 v76, v73
    v_exp_f32_e32 v143, v143
    v_mul_f32_e64 v77, -v74, v76
    v_pk_fma_f32 v[128:129], v[128:129], s[34:35], s[34:35]
    v_pk_fma_f32 v[130:131], v[130:131], s[34:35], s[34:35]
    v_pk_fma_f32 v[132:133], v[132:133], s[34:35], s[34:35]
    v_pk_fma_f32 v[134:135], v[134:135], s[34:35], s[34:35]
    v_pk_fma_f32 v[136:137], v[136:137], s[34:35], s[34:35]
    v_pk_fma_f32 v[138:139], v[138:139], s[34:35], s[34:35]
    v_pk_fma_f32 v[140:141], v[140:141], s[34:35], s[34:35]
    v_pk_fma_f32 v[142:143], v[142:143], s[34:35], s[34:35]
    v_pk_fma_f32 v[80:81], v[80:81], v[76:77], v[76:77] op_sel:[0,0,1] op_sel_hi:[1,0,1]
    v_pk_fma_f32 v[82:83], v[82:83], v[76:77], v[76:77] op_sel:[0,0,1] op_sel_hi:[1,0,1]
    v_pk_fma_f32 v[84:85], v[84:85], v[76:77], v[76:77] op_sel:[0,0,1] op_sel_hi:[1,0,1]
    v_pk_fma_f32 v[86:87], v[86:87], v[76:77], v[76:77] op_sel:[0,0,1] op_sel_hi:[1,0,1]
    v_pk_fma_f32 v[88:89], v[88:89], v[76:77], v[76:77] op_sel:[0,0,1] op_sel_hi:[1,0,1]
    v_pk_fma_f32 v[90:91], v[90:91], v[76:77], v[76:77] op_sel:[0,0,1] op_sel_hi:[1,0,1]
    v_pk_fma_f32 v[92:93], v[92:93], v[76:77], v[76:77] op_sel:[0,0,1] op_sel_hi:[1,0,1]
    v_pk_fma_f32 v[94:95], v[94:95], v[76:77], v[76:77] op_sel:[0,0,1] op_sel_hi:[1,0,1]
    v_pk_fma_f32 v[96:97], v[96:97], v[76:77], v[76:77] op_sel:[0,0,1] op_sel_hi:[1,0,1]
    v_pk_fma_f32 v[98:99], v[98:99], v[76:77], v[76:77] op_sel:[0,0,1] op_sel_hi:[1,0,1]
    v_pk_fma_f32 v[100:101], v[100:101], v[76:77], v[76:77] op_sel:[0,0,1] op_sel_hi:[1,0,1]
    v_pk_fma_f32 v[102:103], v[102:103], v[76:77], v[76:77] op_sel:[0,0,1] op_sel_hi:[1,0,1]
    v_mfma_f32_32x32x16_bf16 v[160:175], a[120:123], v[104:107], 0
    s_add_u32 m0, s40, s80
    ds_read_b64_tr_b16 v[244:245], v22 offset:27648
    ds_read_b64_tr_b16 v[246:247], v22 offset:29184
    ds_read_b64_tr_b16 v[248:249], v23 offset:27712
    v_cvt_pk_bf16_f32 v80, v80, v81
    v_cvt_pk_bf16_f32 v81, v82, v83
    v_cvt_pk_bf16_f32 v82, v84, v85
    v_cvt_pk_bf16_f32 v83, v86, v87
    v_mfma_f32_32x32x16_bf16 v[160:175], a[124:127], v[108:111], v[160:175]
    s_mov_b32 s59, s16
    ds_read_b64_tr_b16 v[250:251], v23 offset:29248
    ds_read_b64_tr_b16 v[252:253], v79 offset:27776
    ds_read_b64_tr_b16 v[254:255], v79 offset:29312
    ds_write_b128 v13, v[80:83]
    v_cvt_pk_bf16_f32 v84, v88, v89
    v_cvt_pk_bf16_f32 v85, v90, v91
    v_cvt_pk_bf16_f32 v86, v92, v93
    v_cvt_pk_bf16_f32 v87, v94, v95
    v_cvt_pk_bf16_f32 v88, v96, v97
    v_mfma_f32_32x32x16_bf16 v[160:175], a[128:131], v[112:115], v[160:175]
    s_mov_b32 s16, s17
    ds_write_b128 v13, v[84:87] offset:1024
    v_cvt_pk_bf16_f32 v89, v98, v99
    v_cvt_pk_bf16_f32 v90, v100, v101
    v_cvt_pk_bf16_f32 v91, v102, v103
    v_rcp_f32_e32 v128, v128
    v_rcp_f32_e32 v129, v129
    v_mfma_f32_32x32x16_bf16 v[160:175], a[132:135], v[116:119], v[160:175]
    s_mov_b32 s17, s18
    ds_write_b128 v13, v[88:91] offset:2048
    v_rcp_f32_e32 v130, v130
    v_mfma_f32_32x32x16_bf16 v[176:191], v[24:27], v[56:59], v[176:191]
    s_mov_b32 s18, s19
    v_rcp_f32_e32 v131, v131
    v_rcp_f32_e32 v132, v132
    v_rcp_f32_e32 v133, v133
    v_rcp_f32_e32 v134, v134
    v_mfma_f32_32x32x16_bf16 v[160:175], a[136:139], v[120:123], v[160:175]
    s_mov_b32 s19, s80
    v_rcp_f32_e32 v135, v135
    v_rcp_f32_e32 v136, v136
    v_rcp_f32_e32 v137, v137
    v_rcp_f32_e32 v138, v138
    v_mfma_f32_32x32x16_bf16 v[160:175], a[140:143], v[124:127], v[160:175]
    s_mov_b32 s80, s59
    v_rcp_f32_e32 v139, v139
    v_rcp_f32_e32 v140, v140
    v_rcp_f32_e32 v141, v141
    v_rcp_f32_e32 v142, v142
    v_rcp_f32_e64 v143, v143
    v_pk_mul_f32 v[144:145], v[144:145], v[128:129]
    v_pk_mul_f32 v[146:147], v[146:147], v[130:131]
    v_pk_mul_f32 v[148:149], v[148:149], v[132:133]
    v_pk_mul_f32 v[150:151], v[150:151], v[134:135]
    v_pk_mul_f32 v[152:153], v[152:153], v[136:137]
    v_pk_mul_f32 v[154:155], v[154:155], v[138:139]
    v_pk_mul_f32 v[156:157], v[156:157], v[140:141]
    v_pk_mul_f32 v[158:159], v[158:159], v[142:143]
    v_pk_fma_f32 v[128:129], v[160:161], v[160:161], s[32:33]
    v_pk_fma_f32 v[130:131], v[162:163], v[162:163], s[32:33]
    v_pk_fma_f32 v[132:133], v[164:165], v[164:165], s[32:33]
    v_pk_fma_f32 v[134:135], v[166:167], v[166:167], s[32:33]
    v_pk_fma_f32 v[136:137], v[168:169], v[168:169], s[32:33]
    v_pk_fma_f32 v[138:139], v[170:171], v[170:171], s[32:33]
    v_pk_fma_f32 v[140:141], v[172:173], v[172:173], s[32:33]
    v_pk_fma_f32 v[142:143], v[174:175], v[174:175], s[32:33]
    v_pk_mul_f32 v[128:129], v[128:129], v[160:161] neg_lo:[1,0] neg_hi:[1,0]
    v_pk_mul_f32 v[130:131], v[130:131], v[162:163] neg_lo:[1,0] neg_hi:[1,0]
    v_pk_mul_f32 v[132:133], v[132:133], v[164:165] neg_lo:[1,0] neg_hi:[1,0]
    v_pk_mul_f32 v[134:135], v[134:135], v[166:167] neg_lo:[1,0] neg_hi:[1,0]
    v_pk_mul_f32 v[136:137], v[136:137], v[168:169] neg_lo:[1,0] neg_hi:[1,0]
    v_pk_mul_f32 v[138:139], v[138:139], v[170:171] neg_lo:[1,0] neg_hi:[1,0]
    v_pk_mul_f32 v[140:141], v[140:141], v[172:173] neg_lo:[1,0] neg_hi:[1,0]
    v_pk_mul_f32 v[142:143], v[142:143], v[174:175] neg_lo:[1,0] neg_hi:[1,0]
    v_mfma_f32_32x32x16_bf16 v[176:191], v[28:31], v[60:63], v[176:191]
    s_cmp_eq_u32 s96, 1
    v_cvt_pk_bf16_f32 v144, v144, v145
    v_cvt_pk_bf16_f32 v145, v146, v147
    v_cvt_pk_bf16_f32 v146, v148, v149
    v_cvt_pk_bf16_f32 v147, v150, v151
    v_cvt_pk_bf16_f32 v148, v152, v153
    v_cvt_pk_bf16_f32 v149, v154, v155
    v_cvt_pk_bf16_f32 v150, v156, v157
    s_waitcnt lgkmcnt(15)
    v_mfma_f32_32x32x16_bf16 v[208:223], a[248:251], v[144:147], v[208:223]
    s_cselect_b32 s100, s16, s18
    v_cvt_pk_bf16_f32 v151, v158, v159
    v_exp_f32_e32 v128, v128
    v_exp_f32_e32 v129, v129
    v_exp_f32_e32 v130, v130
    v_mfma_f32_32x32x16_bf16 v[192:207], a[244:247], v[144:147], v[192:207]
    s_cselect_b32 s101, s18, s16
    s_waitcnt lgkmcnt(0)
    s_barrier
    ds_read_b128 v[104:107], v12
    ds_read_b128 v[108:111], v12 offset:1024
    ds_read_b128 v[112:115], v12 offset:2048
    v_exp_f32_e32 v131, v131
    v_mfma_f32_32x32x16_bf16 v[176:191], a[240:243], v[144:147], v[176:191]
    s_sub_u32 s60, s17, s100
    ds_read_b128 v[116:119], v12 offset:4096
    ds_read_b128 v[120:123], v12 offset:5120
    ds_read_b128 v[124:127], v12 offset:6144
    v_exp_f32_e32 v132, v132
    v_exp_f32_e32 v133, v133
    v_mfma_f32_32x32x16_bf16 v[208:223], v[228:231], v[148:151], v[208:223]
    v_exp_f32_e32 v134, v134
    v_exp_f32_e32 v135, v135
    v_exp_f32_e32 v136, v136
    v_exp_f32_e32 v137, v137
    v_mfma_f32_32x32x16_bf16 v[192:207], v[224:227], v[148:151], v[192:207]
    v_exp_f32_e32 v138, v138
    v_exp_f32_e32 v139, v139
    v_exp_f32_e32 v140, v140
    v_exp_f32_e32 v141, v141
    v_mfma_f32_32x32x16_bf16 v[176:191], a[252:255], v[148:151], v[176:191]
    s_waitcnt lgkmcnt(3)
    v_exp_f32_e32 v142, v142
    v_exp_f32_e32 v143, v143
    v_lshrrev_b32_e32 v22, 14, v15
    v_lshlrev_b32_e32 v22, 2, v22
    v_add_u32_e32 v22, 0x27e00, v22
    v_mov_b32_e32 v23, s75
    v_mov_b32_e32 v79, 0
    v_pk_fma_f32 v[128:129], v[128:129], s[34:35], s[34:35]
    v_pk_fma_f32 v[130:131], v[130:131], s[34:35], s[34:35]
    v_pk_fma_f32 v[132:133], v[132:133], s[34:35], s[34:35]
    v_pk_fma_f32 v[134:135], v[134:135], s[34:35], s[34:35]
    v_pk_fma_f32 v[136:137], v[136:137], s[34:35], s[34:35]
    v_pk_fma_f32 v[138:139], v[138:139], s[34:35], s[34:35]
    v_pk_fma_f32 v[140:141], v[140:141], s[34:35], s[34:35]
    v_pk_fma_f32 v[142:143], v[142:143], s[34:35], s[34:35]
    v_mfma_f32_32x32x16_bf16 v[144:159], a[0:3], v[104:107], 0
    s_waitcnt lgkmcnt(0)
    v_mov_b32_e32 v72, 4.0
    v_cndmask_b32_e64 v76, v16, 4.0, s[56:57]
    v_cndmask_b32_e64 v77, v19, 4.0, s[38:39]
    v_rcp_f32_e32 v128, v128
    v_rcp_f32_e32 v129, v129
    v_mfma_f32_32x32x16_bf16 v[144:159], a[4:7], v[108:111], v[144:159]
    buffer_load_dwordx4 v17, s[24:27], s47 offen offset:1024 nt lds
    v_rcp_f32_e32 v130, v130
    v_rcp_f32_e32 v131, v131
    v_rcp_f32_e32 v132, v132
    v_rcp_f32_e32 v133, v133
    v_mfma_f32_32x32x16_bf16 v[144:159], a[8:11], v[112:115], v[144:159]
    s_sub_u32 s59, s49, s99
    buffer_load_dwordx4 v18, s[24:27], s47 offen offset:2048 nt lds
    v_rcp_f32_e32 v134, v134
    v_rcp_f32_e32 v135, v135
    v_rcp_f32_e32 v136, v136
    v_mfma_f32_32x32x16_bf16 v[144:159], a[12:15], v[116:119], v[144:159]
    s_sub_u32 s51, s51, 1
    buffer_load_dwordx4 v76, s[24:27], s47 offen nt lds
    v_rcp_f32_e32 v137, v137
    v_rcp_f32_e32 v138, v138
    v_rcp_f32_e32 v139, v139
    v_rcp_f32_e32 v140, v140
    v_mfma_f32_32x32x16_bf16 v[144:159], a[16:19], v[120:123], v[144:159]
    s_cmp_lg_u32 s51, 0
    s_mov_b32 exec_hi, 0
    buffer_load_dwordx4 v77, s[24:27], s47 offen offset:3072 nt lds
    s_mov_b32 exec_hi, -1
    v_rcp_f32_e32 v141, v141
    v_rcp_f32_e32 v142, v142
    v_mfma_f32_32x32x16_bf16 v[144:159], a[20:23], v[124:127], v[144:159]
.p2align 6
L_loop:
    v_rcp_f32_e32 v143, v143
    v_add_u32_e32 v0, s100, v4
    v_add_u32_e32 v2, s101, v6
    v_add_u32_e32 v3, s101, v7
    v_mad_i32_i24 v0, v8, s60, v0
    v_add_u32_e32 v1, v0, v5
    v_add_u32_e32 v79, 1, v79
    v_pk_mul_f32 v[160:161], v[160:161], v[128:129]
    v_pk_mul_f32 v[162:163], v[162:163], v[130:131]
    v_pk_mul_f32 v[164:165], v[164:165], v[132:133]
    v_pk_mul_f32 v[166:167], v[166:167], v[134:135]
    v_pk_mul_f32 v[168:169], v[168:169], v[136:137]
    v_pk_mul_f32 v[170:171], v[170:171], v[138:139]
    v_pk_mul_f32 v[172:173], v[172:173], v[140:141]
    v_pk_mul_f32 v[174:175], v[174:175], v[142:143]
    v_pk_fma_f32 v[128:129], v[144:145], v[144:145], s[32:33]
    v_pk_fma_f32 v[130:131], v[146:147], v[146:147], s[32:33]
    v_pk_fma_f32 v[132:133], v[148:149], v[148:149], s[32:33]
    v_pk_fma_f32 v[134:135], v[150:151], v[150:151], s[32:33]
    v_pk_fma_f32 v[136:137], v[152:153], v[152:153], s[32:33]
    v_pk_fma_f32 v[138:139], v[154:155], v[154:155], s[32:33]
    v_pk_fma_f32 v[140:141], v[156:157], v[156:157], s[32:33]
    v_pk_fma_f32 v[142:143], v[158:159], v[158:159], s[32:33]
    v_pk_mul_f32 v[128:129], v[128:129], v[144:145] neg_lo:[1,0] neg_hi:[1,0]
    v_pk_mul_f32 v[130:131], v[130:131], v[146:147] neg_lo:[1,0] neg_hi:[1,0]
    v_pk_mul_f32 v[132:133], v[132:133], v[148:149] neg_lo:[1,0] neg_hi:[1,0]
    v_pk_mul_f32 v[134:135], v[134:135], v[150:151] neg_lo:[1,0] neg_hi:[1,0]
    v_pk_mul_f32 v[136:137], v[136:137], v[152:153] neg_lo:[1,0] neg_hi:[1,0]
    v_pk_mul_f32 v[138:139], v[138:139], v[154:155] neg_lo:[1,0] neg_hi:[1,0]
    v_pk_mul_f32 v[140:141], v[140:141], v[156:157] neg_lo:[1,0] neg_hi:[1,0]
    v_pk_mul_f32 v[142:143], v[142:143], v[158:159] neg_lo:[1,0] neg_hi:[1,0]
    v_cvt_pk_bf16_f32 v160, v160, v161
    v_cvt_pk_bf16_f32 v161, v162, v163
    v_cvt_pk_bf16_f32 v162, v164, v165
    v_cvt_pk_bf16_f32 v163, v166, v167
    v_cvt_pk_bf16_f32 v164, v168, v169
    v_cvt_pk_bf16_f32 v165, v170, v171
    s_cmp_lt_u32 s59, 2
    v_mfma_f32_32x32x16_bf16 v[208:223], v[240:243], v[160:163], v[208:223]
    s_cbranch_scc1 L_border
L_border_ret:
    ds_read_b128 v[52:55], v9
    ds_read2_b64 v[44:47], v0 offset0:0 offset1:24
    ds_read2_b64 v[48:51], v1 offset0:0 offset1:24
    ds_read2_b64 v[68:71], v3 offset0:0 offset1:1
    v_cvt_pk_bf16_f32 v166, v172, v173
    v_cvt_pk_bf16_f32 v167, v174, v175
    v_exp_f32_e32 v128, v128
    v_exp_f32_e32 v129, v129
    v_mfma_f32_32x32x16_bf16 v[208:223], v[252:255], v[164:167], v[208:223]
    s_cmp_eq_u32 s50, 0
    ds_read_b128 v[64:67], v9 offset:1024
    ds_read2_b64 v[56:59], v0 offset0:50 offset1:74
    ds_read2_b64 v[60:63], v2 offset0:0 offset1:24
    v_exp_f32_e32 v130, v130
    v_exp_f32_e32 v131, v131
    v_mfma_f32_32x32x16_bf16 v[192:207], v[236:239], v[160:163], v[192:207]
    s_cselect_b64 s[56:57], s[52:53], 0
    v_exp_f32_e32 v132, v132
    v_exp_f32_e32 v133, v133
    v_exp_f32_e32 v134, v134
    v_exp_f32_e32 v135, v135
    v_mfma_f32_32x32x16_bf16 v[192:207], v[248:251], v[164:167], v[192:207]
    v_cvt_pk_bf16_f32 v208, v208, v209
    v_cvt_pk_bf16_f32 v209, v210, v211
    v_cvt_pk_bf16_f32 v210, v212, v213
    v_cvt_pk_bf16_f32 v211, v214, v215
    v_cvt_pk_bf16_f32 v212, v216, v217
    v_cvt_pk_bf16_f32 v213, v218, v219
    v_cvt_pk_bf16_f32 v214, v220, v221
    s_waitcnt lgkmcnt(3)
    v_mfma_f32_16x16x16_bf16 v[80:83], v[32:33], v[68:69], 0
    v_cvt_pk_bf16_f32 v215, v222, v223
    v_exp_f32_e32 v136, v136
    v_mfma_f32_16x16x16_bf16 v[84:87], v[34:35], v[70:71], 0
    v_exp_f32_e32 v137, v137
    v_cvt_pk_bf16_f32 v200, v200, v201
    v_cvt_pk_bf16_f32 v201, v202, v203
    v_cvt_pk_bf16_f32 v202, v204, v205
    v_cvt_pk_bf16_f32 v203, v206, v207
    v_mfma_f32_32x32x16_bf16 v[176:191], v[232:235], v[160:163], v[176:191]
    s_cmp_eq_u32 s50, 11
    ds_read2_b64 v[68:71], v3 offset0:2 offset1:3
    ds_write_b128 v10, v[208:211] offset:1024
    v_exp_f32_e32 v138, v138
    v_exp_f32_e32 v139, v139
    v_exp_f32_e32 v140, v140
    v_exp_f32_e32 v141, v141
    v_mfma_f32_32x32x16_bf16 v[176:191], v[244:247], v[164:167], v[176:191]
    s_cselect_b64 s[38:39], s[54:55], 0
    ds_write_b128 v10, v[212:215] offset:2048
    v_exp_f32_e32 v142, v142
    v_exp_f32_e64 v143, v143
    v_pk_fma_f32 v[128:129], v[128:129], s[34:35], s[34:35]
    v_pk_fma_f32 v[130:131], v[130:131], s[34:35], s[34:35]
    v_pk_fma_f32 v[132:133], v[132:133], s[34:35], s[34:35]
    v_pk_fma_f32 v[134:135], v[134:135], s[34:35], s[34:35]
    v_pk_fma_f32 v[136:137], v[136:137], s[34:35], s[34:35]
    v_pk_fma_f32 v[138:139], v[138:139], s[34:35], s[34:35]
    v_pk_fma_f32 v[140:141], v[140:141], s[34:35], s[34:35]
    v_pk_fma_f32 v[142:143], v[142:143], s[34:35], s[34:35]
    v_mfma_f32_32x32x16_bf16 v[160:175], a[24:27], v[104:107], 0
    s_waitcnt lgkmcnt(1)
    ds_write_b128 v10, v[200:203]
    ds_write_b32 v23, v79
    v_cndmask_b32_e64 v76, v16, 4.0, s[56:57]
    v_mfma_f32_32x32x16_bf16 v[160:175], a[28:31], v[108:111], v[160:175]
    s_cmp_le_u32 s51, 2
    v_cndmask_b32_e64 v77, v19, 4.0, s[38:39]
    v_rcp_f32_e32 v128, v128
    v_rcp_f32_e32 v129, v129
    v_rcp_f32_e32 v130, v130
    v_smfmac_f32_16x16x64_bf16 v[80:83], v[52:55], v[44:51], v15
    ds_read_b128 v[52:55], v9 offset:2048
    ds_read2_b64 v[44:47], v0 offset0:1 offset1:25
    ds_read2_b64 v[48:51], v1 offset0:1 offset1:25
    v_mfma_f32_32x32x16_bf16 v[160:175], a[32:35], v[112:115], v[160:175]
    s_cselect_b32 s26, 0, s26
    v_rcp_f32_e32 v131, v131
    v_rcp_f32_e32 v132, v132
    v_rcp_f32_e32 v133, v133
    v_smfmac_f32_16x16x64_bf16 v[80:83], v[64:67], v[56:63], v15
    ds_read_b128 v[64:67], v9 offset:3072
    ds_read2_b64 v[56:59], v0 offset0:51 offset1:75
    ds_read2_b64 v[60:63], v2 offset0:1 offset1:25
    v_mfma_f32_32x32x16_bf16 v[160:175], a[36:39], v[116:119], v[160:175]
    s_add_u32 m0, s40, s80
    v_rcp_f32_e32 v134, v134
    v_rcp_f32_e32 v135, v135
    v_rcp_f32_e32 v136, v136
    v_mfma_f32_32x32x16_bf16 v[160:175], a[40:43], v[120:123], v[160:175]
    s_waitcnt lgkmcnt(6)
    v_rcp_f32_e32 v137, v137
    v_rcp_f32_e32 v138, v138
    v_rcp_f32_e32 v139, v139
    v_rcp_f32_e32 v140, v140
    s_waitcnt lgkmcnt(3)
    v_smfmac_f32_16x16x64_bf16 v[84:87], v[52:55], v[44:51], v15
    ds_read_b128 v[52:55], v9 offset:4096
    ds_read2_b64 v[44:47], v0 offset0:2 offset1:26
    ds_read2_b64 v[48:51], v1 offset0:2 offset1:26
    v_mfma_f32_32x32x16_bf16 v[160:175], a[44:47], v[124:127], v[160:175]
    ds_read_b32 v78, v22
    ds_read_b128 v[100:103], v11 offset:2048
    ds_read_b128 v[92:95], v11
    ds_read_b128 v[96:99], v11 offset:1024
    v_rcp_f32_e32 v141, v141
    v_rcp_f32_e32 v142, v142
    v_rcp_f32_e32 v143, v143
    v_pk_mul_f32 v[144:145], v[144:145], v[128:129]
    v_pk_mul_f32 v[146:147], v[146:147], v[130:131]
    v_pk_mul_f32 v[148:149], v[148:149], v[132:133]
    v_pk_mul_f32 v[150:151], v[150:151], v[134:135]
    v_pk_mul_f32 v[152:153], v[152:153], v[136:137]
    v_pk_mul_f32 v[154:155], v[154:155], v[138:139]
    v_pk_mul_f32 v[156:157], v[156:157], v[140:141]
    v_pk_mul_f32 v[158:159], v[158:159], v[142:143]
    v_pk_add_f32 v[72:73], v[80:81], v[82:83]
    v_pk_mul_f32 v[74:75], v[80:81], v[80:81]
    v_pk_fma_f32 v[74:75], v[82:83], v[82:83], v[74:75]
    v_pk_fma_f32 v[128:129], v[160:161], v[160:161], s[32:33]
    v_pk_fma_f32 v[130:131], v[162:163], v[162:163], s[32:33]
    v_pk_fma_f32 v[132:133], v[164:165], v[164:165], s[32:33]
    v_pk_fma_f32 v[134:135], v[166:167], v[166:167], s[32:33]
    v_pk_fma_f32 v[136:137], v[168:169], v[168:169], s[32:33]
    v_pk_fma_f32 v[138:139], v[170:171], v[170:171], s[32:33]
    v_pk_fma_f32 v[140:141], v[172:173], v[172:173], s[32:33]
    v_pk_fma_f32 v[142:143], v[174:175], v[174:175], s[32:33]
    v_pk_mul_f32 v[128:129], v[128:129], v[160:161] neg_lo:[1,0] neg_hi:[1,0]
    v_pk_mul_f32 v[130:131], v[130:131], v[162:163] neg_lo:[1,0] neg_hi:[1,0]
    v_pk_mul_f32 v[132:133], v[132:133], v[164:165] neg_lo:[1,0] neg_hi:[1,0]
    v_pk_mul_f32 v[134:135], v[134:135], v[166:167] neg_lo:[1,0] neg_hi:[1,0]
    v_pk_mul_f32 v[136:137], v[136:137], v[168:169] neg_lo:[1,0] neg_hi:[1,0]
    v_pk_mul_f32 v[138:139], v[138:139], v[170:171] neg_lo:[1,0] neg_hi:[1,0]
    v_pk_mul_f32 v[140:141], v[140:141], v[172:173] neg_lo:[1,0] neg_hi:[1,0]
    v_pk_mul_f32 v[142:143], v[142:143], v[174:175] neg_lo:[1,0] neg_hi:[1,0]
    v_cvt_pk_bf16_f32 v144, v144, v145
    v_cvt_pk_bf16_f32 v145, v146, v147
    v_cvt_pk_bf16_f32 v146, v148, v149
    v_cvt_pk_bf16_f32 v147, v150, v151
    s_waitcnt lgkmcnt(7)
    v_smfmac_f32_16x16x64_bf16 v[84:87], v[64:67], v[56:63], v15
    ds_read_b128 v[64:67], v9 offset:5120
    ds_read2_b64 v[56:59], v0 offset0:52 offset1:76
    ds_read2_b64 v[60:63], v2 offset0:2 offset1:26
    v_mfma_f32_32x32x16_bf16 v[208:223], a[152:155], v[144:147], 0
    s_waitcnt lgkmcnt(3)
    v_cmp_ne_u32_e32 vcc, v78, v79
    v_cvt_pk_bf16_f32 v148, v152, v153
    v_cvt_pk_bf16_f32 v149, v154, v155
    v_cvt_pk_bf16_f32 v150, v156, v157
    v_cvt_pk_bf16_f32 v151, v158, v159
    v_exp_f32_e32 v128, v128
    v_exp_f32_e32 v129, v129
    v_mfma_f32_32x32x16_bf16 v[208:223], a[164:167], v[148:151], v[208:223]
    s_cbranch_vccnz L_slow0
L_slow0_ret:
    v_exp_f32_e32 v130, v130
    v_exp_f32_e32 v131, v131
    v_exp_f32_e32 v132, v132
    v_mfma_f32_32x32x16_bf16 v[192:207], v[24:27], v[100:103], v[192:207]
    v_exp_f32_e32 v133, v133
    v_exp_f32_e32 v134, v134
    v_exp_f32_e32 v135, v135
    v_mfma_f32_32x32x16_bf16 v[176:191], v[24:27], v[92:95], v[176:191]
    v_exp_f32_e32 v136, v136
    v_exp_f32_e32 v137, v137
    v_exp_f32_e32 v138, v138
    v_mfma_f32_32x32x16_bf16 v[176:191], v[28:31], v[96:99], v[176:191]
    s_waitcnt lgkmcnt(0)
    v_exp_f32_e32 v139, v139
    v_exp_f32_e32 v140, v140
    v_exp_f32_e32 v141, v141
    v_mfma_f32_16x16x16_bf16 v[88:91], v[36:37], v[68:69], 0
    v_cvt_pk_bf16_f32 v100, v192, v193
    v_cvt_pk_bf16_f32 v101, v194, v195
    v_cvt_pk_bf16_f32 v102, v196, v197
    v_cvt_pk_bf16_f32 v103, v198, v199
    v_fma_f32 v128, v128, s34, s34
    v_mfma_f32_32x32x16_bf16 v[192:207], a[148:151], v[144:147], 0
    v_exp_f32_e32 v142, v142
    v_exp_f32_e64 v143, v143
    v_cvt_pk_bf16_f32 v92, v176, v177
    v_cvt_pk_bf16_f32 v93, v178, v179
    v_smfmac_f32_16x16x64_bf16 v[88:91], v[52:55], v[44:51], v15
    ds_read_b128 v[52:55], v9 offset:6144
    ds_read2_b64 v[44:47], v0 offset0:3 offset1:27
    ds_read2_b64 v[48:51], v1 offset0:3 offset1:27
    v_mfma_f32_32x32x16_bf16 v[192:207], a[160:163], v[148:151], v[192:207]
    v_cvt_pk_bf16_f32 v94, v180, v181
    v_cvt_pk_bf16_f32 v95, v182, v183
    v_cvt_pk_bf16_f32 v96, v184, v185
    v_cvt_pk_bf16_f32 v97, v186, v187
    v_cvt_pk_bf16_f32 v98, v188, v189
    v_cvt_pk_bf16_f32 v99, v190, v191
    v_mfma_f32_32x32x16_bf16 v[176:191], a[144:147], v[144:147], 0
    ds_write_b128 v20, v[100:103] offset:64
    v_fma_f32 v129, v129, s34, s34
    v_mfma_f32_32x32x16_bf16 v[176:191], a[156:159], v[148:151], v[176:191]
    ds_write_b128 v20, v[92:95]
    v_fma_f32 v130, v130, s34, s34
    v_fma_f32 v131, v131, s34, s34
    v_fma_f32 v132, v132, s34, s34
    v_fma_f32 v133, v133, s34, s34
    v_pk_fma_f32 v[134:135], v[134:135], s[34:35], s[34:35]
    v_pk_fma_f32 v[136:137], v[136:137], s[34:35], s[34:35]
    v_pk_fma_f32 v[138:139], v[138:139], s[34:35], s[34:35]
    v_pk_fma_f32 v[140:141], v[140:141], s[34:35], s[34:35]
    v_pk_fma_f32 v[142:143], v[142:143], s[34:35], s[34:35]
    v_pk_add_f32 v[72:73], v[72:73], v[84:85]
    v_pk_fma_f32 v[74:75], v[84:85], v[84:85], v[74:75]
    v_pk_add_f32 v[72:73], v[72:73], v[86:87]
    v_pk_fma_f32 v[74:75], v[86:87], v[86:87], v[74:75]
    v_mfma_f32_32x32x16_bf16 v[144:159], a[48:51], v[104:107], 0
    s_waitcnt lgkmcnt(2)
    v_rcp_f32_e32 v128, v128
    v_rcp_f32_e32 v129, v129
    v_rcp_f32_e32 v130, v130
    v_smfmac_f32_16x16x64_bf16 v[88:91], v[64:67], v[56:63], v15
    ds_read_b128 v[64:67], v9 offset:7168
    ds_read2_b64 v[56:59], v0 offset0:53 offset1:77
    ds_read2_b64 v[60:63], v2 offset0:3 offset1:27
    v_mfma_f32_32x32x16_bf16 v[144:159], a[52:55], v[108:111], v[144:159]
    s_waitcnt lgkmcnt(3)
    ds_write_b128 v20, v[96:99] offset:32
    v_mul_f32_e32 v160, v160, v128
    v_mfma_f32_16x16x16_bf16 v[92:95], v[38:39], v[70:71], 0
    v_rcp_f32_e32 v131, v131
    v_rcp_f32_e32 v132, v132
    v_mul_f32_e32 v161, v161, v129
    v_mfma_f32_32x32x16_bf16 v[144:159], a[56:59], v[112:115], v[144:159]
    ds_read2_b64 v[68:71], v3 offset0:4 offset1:5
    v_rcp_f32_e32 v133, v133
    v_rcp_f32_e32 v134, v134
    v_mul_f32_e32 v162, v162, v130
    v_mfma_f32_32x32x16_bf16 v[144:159], a[60:63], v[116:119], v[144:159]
    v_rcp_f32_e32 v135, v135
    v_rcp_f32_e32 v136, v136
    v_rcp_f32_e32 v137, v137
    v_smfmac_f32_16x16x64_bf16 v[92:95], v[52:55], v[44:51], v15
    ds_read_b128 v[52:55], v9 offset:8192
    ds_read2_b64 v[44:47], v0 offset0:4 offset1:28
    ds_read2_b64 v[48:51], v1 offset0:4 offset1:28
    v_mfma_f32_32x32x16_bf16 v[144:159], a[64:67], v[120:123], v[144:159]
    s_waitcnt lgkmcnt(4)
    v_rcp_f32_e32 v138, v138
    v_rcp_f32_e32 v139, v139
    v_rcp_f32_e32 v140, v140
    v_smfmac_f32_16x16x64_bf16 v[92:95], v[64:67], v[56:63], v15
    ds_read_b128 v[64:67], v9 offset:9216
    ds_read2_b64 v[56:59], v0 offset0:54 offset1:78
    ds_read2_b64 v[60:63], v2 offset0:4 offset1:28
    v_mfma_f32_32x32x16_bf16 v[144:159], a[68:71], v[124:127], v[144:159]
    s_mov_b32 exec_hi, 0
    buffer_load_dwordx4 v77, s[24:27], s48 offen offset:3072 nt lds
    s_mov_b32 exec_hi, -1
    v_rcp_f32_e32 v141, v141
    v_rcp_f32_e32 v142, v142
    v_rcp_f32_e32 v143, v143
    v_mul_f32_e64 v163, v163, v131
    v_pk_mul_f32 v[164:165], v[164:165], v[132:133]
    v_pk_mul_f32 v[166:167], v[166:167], v[134:135]
    v_pk_mul_f32 v[168:169], v[168:169], v[136:137]
    v_pk_mul_f32 v[170:171], v[170:171], v[138:139]
    v_pk_mul_f32 v[172:173], v[172:173], v[140:141]
    v_pk_mul_f32 v[174:175], v[174:175], v[142:143]
    v_pk_add_f32 v[72:73], v[72:73], v[88:89]
    v_pk_fma_f32 v[74:75], v[88:89], v[88:89], v[74:75]
    v_pk_add_f32 v[72:73], v[72:73], v[90:91]
    v_pk_fma_f32 v[74:75], v[90:91], v[90:91], v[74:75]
    v_pk_fma_f32 v[128:129], v[144:145], v[144:145], s[32:33]
    v_pk_fma_f32 v[130:131], v[146:147], v[146:147], s[32:33]
    v_pk_fma_f32 v[132:133], v[148:149], v[148:149], s[32:33]
    v_pk_fma_f32 v[134:135], v[150:151], v[150:151], s[32:33]
    v_pk_fma_f32 v[136:137], v[152:153], v[152:153], s[32:33]
    v_pk_fma_f32 v[138:139], v[154:155], v[154:155], s[32:33]
    v_pk_fma_f32 v[140:141], v[156:157], v[156:157], s[32:33]
    v_pk_fma_f32 v[142:143], v[158:159], v[158:159], s[32:33]
    v_pk_mul_f32 v[128:129], v[128:129], v[144:145] neg_lo:[1,0] neg_hi:[1,0]
    v_pk_mul_f32 v[130:131], v[130:131], v[146:147] neg_lo:[1,0] neg_hi:[1,0]
    v_pk_mul_f32 v[132:133], v[132:133], v[148:149] neg_lo:[1,0] neg_hi:[1,0]
    v_pk_mul_f32 v[134:135], v[134:135], v[150:151] neg_lo:[1,0] neg_hi:[1,0]
    v_pk_mul_f32 v[136:137], v[136:137], v[152:153] neg_lo:[1,0] neg_hi:[1,0]
    v_pk_mul_f32 v[138:139], v[138:139], v[154:155] neg_lo:[1,0] neg_hi:[1,0]
    v_pk_mul_f32 v[140:141], v[140:141], v[156:157] neg_lo:[1,0] neg_hi:[1,0]
    v_pk_mul_f32 v[142:143], v[142:143], v[158:159] neg_lo:[1,0] neg_hi:[1,0]
    s_waitcnt lgkmcnt(6)
    v_mfma_f32_16x16x16_bf16 v[96:99], v[40:41], v[68:69], 0
    v_cvt_pk_bf16_f32 v160, v160, v161
    v_cvt_pk_bf16_f32 v161, v162, v163
    v_cvt_pk_bf16_f32 v162, v164, v165
    v_mfma_f32_16x16x16_bf16 v[100:103], v[42:43], v[70:71], 0
    v_cvt_pk_bf16_f32 v163, v166, v167
    v_cvt_pk_bf16_f32 v164, v168, v169
    v_cvt_pk_bf16_f32 v165, v170, v171
    v_cvt_pk_bf16_f32 v166, v172, v173
    v_cvt_pk_bf16_f32 v167, v174, v175
    v_mfma_f32_32x32x16_bf16 v[208:223], a[176:179], v[160:163], v[208:223]
    s_waitcnt lgkmcnt(0)
    v_exp_f32_e32 v128, v128
    v_exp_f32_e32 v129, v129
    v_exp_f32_e32 v130, v130
    v_mfma_f32_32x32x16_bf16 v[192:207], a[172:175], v[160:163], v[192:207]
    buffer_load_dwordx4 v76, s[24:27], s48 offen nt lds
    v_exp_f32_e32 v131, v131
    v_exp_f32_e32 v132, v132
    v_fma_f32 v128, v128, s34, s34
    v_smfmac_f32_16x16x64_bf16 v[96:99], v[52:55], v[44:51], v15
    ds_read_b128 v[52:55], v9 offset:10240
    ds_read2_b64 v[44:47], v0 offset0:5 offset1:29
    ds_read2_b64 v[48:51], v1 offset0:5 offset1:29
    v_mfma_f32_32x32x16_bf16 v[176:191], a[168:171], v[160:163], v[176:191]
    v_exp_f32_e32 v133, v133
    v_exp_f32_e32 v134, v134
    v_exp_f32_e32 v135, v135
    v_mfma_f32_32x32x16_bf16 v[208:223], a[188:191], v[164:167], v[208:223]
    v_exp_f32_e32 v136, v136
    v_exp_f32_e32 v137, v137
    v_exp_f32_e32 v138, v138
    v_smfmac_f32_16x16x64_bf16 v[96:99], v[64:67], v[56:63], v15
    ds_read_b128 v[64:67], v9 offset:11264
    ds_read2_b64 v[56:59], v0 offset0:55 offset1:79
    ds_read2_b64 v[60:63], v2 offset0:5 offset1:29
    v_mfma_f32_32x32x16_bf16 v[192:207], a[184:187], v[164:167], v[192:207]
    v_exp_f32_e32 v139, v139
    v_exp_f32_e32 v140, v140
    v_exp_f32_e32 v141, v141
    v_mfma_f32_32x32x16_bf16 v[176:191], a[180:183], v[164:167], v[176:191]
    s_waitcnt lgkmcnt(4)
    buffer_load_dwordx4 v17, s[24:27], s48 offen offset:1024 nt lds
    v_exp_f32_e32 v142, v142
    v_exp_f32_e64 v143, v143
    v_fma_f32 v129, v129, s34, s34
    v_fma_f32 v130, v130, s34, s34
    v_fma_f32 v131, v131, s34, s34
    v_fma_f32 v132, v132, s34, s34
    v_fma_f32 v133, v133, s34, s34
    v_pk_fma_f32 v[134:135], v[134:135], s[34:35], s[34:35]
    v_pk_fma_f32 v[136:137], v[136:137], s[34:35], s[34:35]
    v_pk_fma_f32 v[138:139], v[138:139], s[34:35], s[34:35]
    v_pk_fma_f32 v[140:141], v[140:141], s[34:35], s[34:35]
    v_pk_fma_f32 v[142:143], v[142:143], s[34:35], s[34:35]
    v_pk_add_f32 v[72:73], v[72:73], v[92:93]
    v_pk_fma_f32 v[74:75], v[92:93], v[92:93], v[74:75]
    v_pk_add_f32 v[72:73], v[72:73], v[94:95]
    v_pk_fma_f32 v[74:75], v[94:95], v[94:95], v[74:75]
    v_mfma_f32_32x32x16_bf16 v[160:175], a[72:75], v[104:107], 0
    s_waitcnt lgkmcnt(1)
    v_add_u32_e32 v78, s16, v21
    v_rcp_f32_e32 v128, v128
    v_rcp_f32_e32 v129, v129
    v_mul_f32_e32 v144, v144, v128
    v_smfmac_f32_16x16x64_bf16 v[100:103], v[52:55], v[44:51], v15
    v_mul_f32_e32 v145, v145, v129
    v_mfma_f32_32x32x16_bf16 v[160:175], a[76:79], v[108:111], v[160:175]
    s_waitcnt lgkmcnt(0)
    v_rcp_f32_e32 v130, v130
    v_rcp_f32_e32 v131, v131
    v_rcp_f32_e32 v132, v132
    v_smfmac_f32_16x16x64_bf16 v[100:103], v[64:67], v[56:63], v15
    v_mul_f32_e32 v146, v146, v130
    v_mfma_f32_32x32x16_bf16 v[160:175], a[80:83], v[112:115], v[160:175]
    ds_read2_b64 v[64:67], v78 offset0:8 offset1:9
    ds_read2_b64 v[56:59], v78 offset0:0 offset1:1
    ds_read2_b64 v[60:63], v78 offset0:4 offset1:5
    v_rcp_f32_e32 v133, v133
    v_mul_f32_e32 v147, v147, v131
    v_mfma_f32_32x32x16_bf16 v[160:175], a[84:87], v[116:119], v[160:175]
    buffer_load_dwordx4 v18, s[24:27], s48 offen offset:2048 nt lds
    v_rcp_f32_e32 v134, v134
    v_rcp_f32_e32 v135, v135
    v_mul_f32_e32 v148, v148, v132
    v_mfma_f32_32x32x16_bf16 v[160:175], a[88:91], v[120:123], v[160:175]
    s_mov_b32 s74, s43
    v_rcp_f32_e32 v136, v136
    v_rcp_f32_e32 v137, v137
    v_rcp_f32_e32 v138, v138
    v_rcp_f32_e32 v139, v139
    v_mfma_f32_32x32x16_bf16 v[160:175], a[92:95], v[124:127], v[160:175]
    s_waitcnt lgkmcnt(0)
    v_rcp_f32_e32 v140, v140
    v_rcp_f32_e32 v141, v141
    v_rcp_f32_e32 v142, v142
    v_rcp_f32_e32 v143, v143
    v_mul_f32_e64 v149, v149, v133
    v_pk_mul_f32 v[150:151], v[150:151], v[134:135]
    v_pk_mul_f32 v[152:153], v[152:153], v[136:137]
    v_pk_mul_f32 v[154:155], v[154:155], v[138:139]
    v_pk_mul_f32 v[156:157], v[156:157], v[140:141]
    v_pk_mul_f32 v[158:159], v[158:159], v[142:143]
    v_pk_add_f32 v[72:73], v[72:73], v[96:97]
    v_pk_fma_f32 v[74:75], v[96:97], v[96:97], v[74:75]
    v_pk_add_f32 v[72:73], v[72:73], v[98:99]
    v_pk_fma_f32 v[74:75], v[98:99], v[98:99], v[74:75]
    v_pk_fma_f32 v[128:129], v[160:161], v[160:161], s[32:33]
    v_pk_fma_f32 v[130:131], v[162:163], v[162:163], s[32:33]
    v_pk_fma_f32 v[132:133], v[164:165], v[164:165], s[32:33]
    v_pk_fma_f32 v[134:135], v[166:167], v[166:167], s[32:33]
    v_pk_fma_f32 v[136:137], v[168:169], v[168:169], s[32:33]
    v_pk_fma_f32 v[138:139], v[170:171], v[170:171], s[32:33]
    v_pk_fma_f32 v[140:141], v[172:173], v[172:173], s[32:33]
    v_pk_fma_f32 v[142:143], v[174:175], v[174:175], s[32:33]
    v_pk_mul_f32 v[128:129], v[128:129], v[160:161] neg_lo:[1,0] neg_hi:[1,0]
    v_pk_mul_f32 v[130:131], v[130:131], v[162:163] neg_lo:[1,0] neg_hi:[1,0]
    v_pk_mul_f32 v[132:133], v[132:133], v[164:165] neg_lo:[1,0] neg_hi:[1,0]
    v_pk_mul_f32 v[134:135], v[134:135], v[166:167] neg_lo:[1,0] neg_hi:[1,0]
    v_pk_mul_f32 v[136:137], v[136:137], v[168:169] neg_lo:[1,0] neg_hi:[1,0]
    v_pk_mul_f32 v[138:139], v[138:139], v[170:171] neg_lo:[1,0] neg_hi:[1,0]
    v_pk_mul_f32 v[140:141], v[140:141], v[172:173] neg_lo:[1,0] neg_hi:[1,0]
    v_pk_mul_f32 v[142:143], v[142:143], v[174:175] neg_lo:[1,0] neg_hi:[1,0]
    v_pk_add_f32 v[72:73], v[72:73], v[100:101]
    v_pk_fma_f32 v[74:75], v[100:101], v[100:101], v[74:75]
    v_pk_add_f32 v[72:73], v[72:73], v[102:103]
    v_pk_fma_f32 v[74:75], v[102:103], v[102:103], v[74:75]
    v_mfma_f32_32x32x16_bf16 v[192:207], v[24:27], v[64:67], v[192:207]
    s_mov_b32 s43, s44
    v_cvt_pk_bf16_f32 v144, v144, v145
    v_cvt_pk_bf16_f32 v145, v146, v147
    v_cvt_pk_bf16_f32 v146, v148, v149
    v_cvt_pk_bf16_f32 v147, v150, v151
    v_add_f32_e32 v72, v72, v73
    v_add_f32_e32 v73, v74, v75
    v_mfma_f32_32x32x16_bf16 v[208:223], a[200:203], v[144:147], v[208:223]
    s_mov_b32 s44, s45
    ds_write_b64 v13, v[72:73] offset:3072
    ds_write_b32 v23, v79 offset:16
    v_cvt_pk_bf16_f32 v148, v152, v153
    v_mfma_f32_32x32x16_bf16 v[192:207], a[196:199], v[144:147], v[192:207]
    s_mov_b32 s45, s46
    v_cvt_pk_bf16_f32 v149, v154, v155
    v_cvt_pk_bf16_f32 v150, v156, v157
    v_cvt_pk_bf16_f32 v151, v158, v159
    v_exp_f32_e32 v128, v128
    v_exp_f32_e32 v129, v129
    v_mfma_f32_32x32x16_bf16 v[176:191], a[192:195], v[144:147], v[176:191]
    s_mov_b32 s46, s47
    v_exp_f32_e32 v130, v130
    v_exp_f32_e32 v131, v131
    v_exp_f32_e32 v132, v132
    v_mfma_f32_32x32x16_bf16 v[208:223], a[212:215], v[148:151], v[208:223]
    s_mov_b32 s47, s48
    v_exp_f32_e32 v133, v133
    v_exp_f32_e32 v134, v134
    v_exp_f32_e32 v135, v135
    v_mfma_f32_32x32x16_bf16 v[192:207], a[208:211], v[148:151], v[192:207]
    s_add_u32 s49, s49, s96
    v_exp_f32_e32 v136, v136
    v_exp_f32_e32 v137, v137
    v_exp_f32_e32 v138, v138
    v_mfma_f32_32x32x16_bf16 v[176:191], a[204:207], v[148:151], v[176:191]
    s_cmp_eq_u32 s49, s97
    v_exp_f32_e32 v139, v139
    v_exp_f32_e32 v140, v140
    v_exp_f32_e32 v141, v141
    v_exp_f32_e32 v142, v142
    v_exp_f32_e64 v143, v143
    v_pk_fma_f32 v[128:129], v[128:129], s[34:35], s[34:35]
    v_pk_fma_f32 v[130:131], v[130:131], s[34:35], s[34:35]
    v_pk_fma_f32 v[132:133], v[132:133], s[34:35], s[34:35]
    v_pk_fma_f32 v[134:135], v[134:135], s[34:35], s[34:35]
    v_pk_fma_f32 v[136:137], v[136:137], s[34:35], s[34:35]
    v_pk_fma_f32 v[138:139], v[138:139], s[34:35], s[34:35]
    v_pk_fma_f32 v[140:141], v[140:141], s[34:35], s[34:35]
    v_pk_fma_f32 v[142:143], v[142:143], s[34:35], s[34:35]
    v_mfma_f32_32x32x16_bf16 v[144:159], a[96:99], v[104:107], 0
    s_cselect_b32 s60, s61, s62
    ds_read_b32 v78, v22 offset:16
    ds_read2st64_b64 v[44:47], v14 offset0:6 offset1:14
    ds_read2st64_b64 v[48:51], v14 offset0:22 offset1:30
    v_rcp_f32_e32 v128, v128
    v_rcp_f32_e32 v129, v129
    v_rcp_f32_e32 v130, v130
    v_mfma_f32_32x32x16_bf16 v[144:159], a[100:103], v[108:111], v[144:159]
    s_cselect_b32 s49, s98, s49
    v_rcp_f32_e32 v131, v131
    v_rcp_f32_e32 v132, v132
    v_rcp_f32_e32 v133, v133
    v_rcp_f32_e32 v134, v134
    v_mfma_f32_32x32x16_bf16 v[144:159], a[104:107], v[112:115], v[144:159]
    s_cselect_b32 s100, s96, 0
    v_rcp_f32_e32 v135, v135
    v_rcp_f32_e32 v136, v136
    v_rcp_f32_e32 v137, v137
    v_rcp_f32_e32 v138, v138
    v_mfma_f32_32x32x16_bf16 v[144:159], a[108:111], v[116:119], v[144:159]
    s_waitcnt lgkmcnt(0)
    v_cmp_ne_u32_e32 vcc, v78, v79
    v_rcp_f32_e32 v139, v139
    v_rcp_f32_e32 v140, v140
    v_rcp_f32_e32 v141, v141
    v_mfma_f32_32x32x16_bf16 v[144:159], a[112:115], v[120:123], v[144:159]
    s_cbranch_vccnz L_slow1
L_slow1_ret:
    v_rcp_f32_e32 v142, v142
    v_add_f32_e32 v72, v44, v46
    v_add_f32_e32 v73, v45, v47
    v_add_f32_e32 v74, v48, v50
    v_add_f32_e32 v75, v49, v51
    v_add_f32_e32 v72, v72, v74
    v_add_f32_e32 v73, v73, v75
    v_mfma_f32_32x32x16_bf16 v[144:159], a[116:119], v[124:127], v[144:159]
    s_add_u32 s50, s50, s100
    v_mul_f32_e32 v74, s36, v72
    v_mul_f32_e32 v73, s37, v73
    v_fma_f32 v73, -v74, v74, v73
    v_max_f32_e32 v73, 0, v73
    v_add_f32_e32 v73, s63, v73
    v_mul_f32_e32 v74, s34, v74
    v_rsq_f32_e32 v76, v73
    v_rcp_f32_e64 v143, v143
    v_mul_f32_e64 v77, -v74, v76
    v_pk_mul_f32 v[160:161], v[160:161], v[128:129]
    v_pk_mul_f32 v[162:163], v[162:163], v[130:131]
    v_pk_mul_f32 v[164:165], v[164:165], v[132:133]
    v_pk_mul_f32 v[166:167], v[166:167], v[134:135]
    v_pk_mul_f32 v[168:169], v[168:169], v[136:137]
    v_pk_mul_f32 v[170:171], v[170:171], v[138:139]
    v_pk_mul_f32 v[172:173], v[172:173], v[140:141]
    v_pk_mul_f32 v[174:175], v[174:175], v[142:143]
    v_pk_fma_f32 v[128:129], v[144:145], v[144:145], s[32:33]
    v_pk_fma_f32 v[130:131], v[146:147], v[146:147], s[32:33]
    v_pk_fma_f32 v[132:133], v[148:149], v[148:149], s[32:33]
    v_pk_fma_f32 v[134:135], v[150:151], v[150:151], s[32:33]
    v_pk_fma_f32 v[136:137], v[152:153], v[152:153], s[32:33]
    v_pk_fma_f32 v[138:139], v[154:155], v[154:155], s[32:33]
    v_pk_fma_f32 v[140:141], v[156:157], v[156:157], s[32:33]
    v_pk_fma_f32 v[142:143], v[158:159], v[158:159], s[32:33]
    v_pk_mul_f32 v[128:129], v[128:129], v[144:145] neg_lo:[1,0] neg_hi:[1,0]
    v_pk_mul_f32 v[130:131], v[130:131], v[146:147] neg_lo:[1,0] neg_hi:[1,0]
    v_pk_mul_f32 v[132:133], v[132:133], v[148:149] neg_lo:[1,0] neg_hi:[1,0]
    v_pk_mul_f32 v[134:135], v[134:135], v[150:151] neg_lo:[1,0] neg_hi:[1,0]
    v_pk_mul_f32 v[136:137], v[136:137], v[152:153] neg_lo:[1,0] neg_hi:[1,0]
    v_pk_mul_f32 v[138:139], v[138:139], v[154:155] neg_lo:[1,0] neg_hi:[1,0]
    v_pk_mul_f32 v[140:141], v[140:141], v[156:157] neg_lo:[1,0] neg_hi:[1,0]
    v_pk_mul_f32 v[142:143], v[142:143], v[158:159] neg_lo:[1,0] neg_hi:[1,0]
    v_pk_fma_f32 v[80:81], v[80:81], v[76:77], v[76:77] op_sel:[0,0,1] op_sel_hi:[1,0,1]
    v_pk_fma_f32 v[82:83], v[82:83], v[76:77], v[76:77] op_sel:[0,0,1] op_sel_hi:[1,0,1]
    v_pk_fma_f32 v[84:85], v[84:85], v[76:77], v[76:77] op_sel:[0,0,1] op_sel_hi:[1,0,1]
    v_pk_fma_f32 v[86:87], v[86:87], v[76:77], v[76:77] op_sel:[0,0,1] op_sel_hi:[1,0,1]
    v_pk_fma_f32 v[88:89], v[88:89], v[76:77], v[76:77] op_sel:[0,0,1] op_sel_hi:[1,0,1]
    v_pk_fma_f32 v[90:91], v[90:91], v[76:77], v[76:77] op_sel:[0,0,1] op_sel_hi:[1,0,1]
    v_pk_fma_f32 v[92:93], v[92:93], v[76:77], v[76:77] op_sel:[0,0,1] op_sel_hi:[1,0,1]
    v_pk_fma_f32 v[94:95], v[94:95], v[76:77], v[76:77] op_sel:[0,0,1] op_sel_hi:[1,0,1]
    v_pk_fma_f32 v[96:97], v[96:97], v[76:77], v[76:77] op_sel:[0,0,1] op_sel_hi:[1,0,1]
    v_pk_fma_f32 v[98:99], v[98:99], v[76:77], v[76:77] op_sel:[0,0,1] op_sel_hi:[1,0,1]
    v_pk_fma_f32 v[100:101], v[100:101], v[76:77], v[76:77] op_sel:[0,0,1] op_sel_hi:[1,0,1]
    v_pk_fma_f32 v[102:103], v[102:103], v[76:77], v[76:77] op_sel:[0,0,1] op_sel_hi:[1,0,1]
    v_mfma_f32_32x32x16_bf16 v[176:191], v[24:27], v[56:59], v[176:191]
    s_add_u32 s48, s48, s60
    ds_read_b128 v[44:47], v10 offset:3072
    ds_read_b128 v[48:51], v10 offset:3856
    ds_read_b128 v[52:55], v10 offset:4640
    ds_read_b128 v[68:71], v10 offset:5424
    v_cvt_pk_bf16_f32 v160, v160, v161
    v_cvt_pk_bf16_f32 v161, v162, v163
    v_cvt_pk_bf16_f32 v162, v164, v165
    v_cvt_pk_bf16_f32 v163, v166, v167
    v_cvt_pk_bf16_f32 v164, v168, v169
    v_cvt_pk_bf16_f32 v165, v170, v171
    v_mfma_f32_32x32x16_bf16 v[208:223], a[224:227], v[160:163], v[208:223]
    s_mov_b32 s59, s16
    v_cvt_pk_bf16_f32 v80, v80, v81
    v_cvt_pk_bf16_f32 v81, v82, v83
    v_cvt_pk_bf16_f32 v82, v84, v85
    v_cvt_pk_bf16_f32 v83, v86, v87
    v_cvt_pk_bf16_f32 v166, v172, v173
    v_cvt_pk_bf16_f32 v167, v174, v175
    v_cvt_pk_bf16_f32 v84, v88, v89
    v_cvt_pk_bf16_f32 v85, v90, v91
    v_cvt_pk_bf16_f32 v86, v92, v93
    v_cvt_pk_bf16_f32 v87, v94, v95
    v_mfma_f32_32x32x16_bf16 v[192:207], a[220:223], v[160:163], v[192:207]
    s_mov_b32 s16, s17
    ds_write_b128 v13, v[80:83]
    v_cvt_pk_bf16_f32 v88, v96, v97
    v_cvt_pk_bf16_f32 v89, v98, v99
    v_cvt_pk_bf16_f32 v90, v100, v101
    v_cvt_pk_bf16_f32 v91, v102, v103
    v_exp_f32_e32 v128, v128
    v_mfma_f32_32x32x16_bf16 v[176:191], a[216:219], v[160:163], v[176:191]
    s_mov_b32 s17, s18
    v_exp_f32_e32 v129, v129
    v_exp_f32_e32 v130, v130
    v_exp_f32_e32 v131, v131
    v_exp_f32_e32 v132, v132
    v_exp_f32_e32 v133, v133
    v_mfma_f32_32x32x16_bf16 v[208:223], a[236:239], v[164:167], v[208:223]
    s_mov_b32 s18, s19
    ds_write_b128 v13, v[84:87] offset:1024
    v_exp_f32_e32 v134, v134
    v_exp_f32_e32 v135, v135
    v_mfma_f32_32x32x16_bf16 v[192:207], a[232:235], v[164:167], v[192:207]
    s_mov_b32 s19, s80
    v_exp_f32_e32 v136, v136
    v_exp_f32_e32 v137, v137
    v_exp_f32_e32 v138, v138
    v_exp_f32_e32 v139, v139
    v_exp_f32_e32 v140, v140
    v_mfma_f32_32x32x16_bf16 v[176:191], a[228:231], v[164:167], v[176:191]
    s_waitcnt vmcnt(4)
    ds_write_b128 v13, v[88:91] offset:2048
    ds_write_b32 v23, v79 offset:32
    v_exp_f32_e32 v141, v141
    v_exp_f32_e32 v142, v142
    v_exp_f32_e64 v143, v143
    v_pk_fma_f32 v[128:129], v[128:129], s[34:35], s[34:35]
    v_pk_fma_f32 v[130:131], v[130:131], s[34:35], s[34:35]
    v_pk_fma_f32 v[132:133], v[132:133], s[34:35], s[34:35]
    v_pk_fma_f32 v[134:135], v[134:135], s[34:35], s[34:35]
    v_pk_fma_f32 v[136:137], v[136:137], s[34:35], s[34:35]
    v_pk_fma_f32 v[138:139], v[138:139], s[34:35], s[34:35]
    v_pk_fma_f32 v[140:141], v[140:141], s[34:35], s[34:35]
    v_pk_fma_f32 v[142:143], v[142:143], s[34:35], s[34:35]
    v_mfma_f32_32x32x16_bf16 v[160:175], a[120:123], v[104:107], 0
    s_waitcnt lgkmcnt(4)
    v_rcp_f32_e32 v128, v128
    v_rcp_f32_e32 v129, v129
    v_rcp_f32_e32 v130, v130
    v_mfma_f32_32x32x16_bf16 v[160:175], a[124:127], v[108:111], v[160:175]
    s_mov_b32 exec_hi, 0xffff
    buffer_store_dwordx4 v[44:47], v14, s[20:23], s74 offen sc1 nt
    buffer_store_dwordx4 v[48:51], v14, s[20:23], s74 offen offset:768 sc1 nt
    s_mov_b32 exec_hi, -1
    v_rcp_f32_e32 v131, v131
    v_mfma_f32_32x32x16_bf16 v[160:175], a[128:131], v[112:115], v[160:175]
    s_mov_b32 s80, s59
    v_rcp_f32_e32 v132, v132
    v_rcp_f32_e32 v133, v133
    v_rcp_f32_e32 v134, v134
    v_mfma_f32_32x32x16_bf16 v[160:175], a[132:135], v[116:119], v[160:175]
    s_cmp_eq_u32 s96, 1
    v_rcp_f32_e32 v135, v135
    v_rcp_f32_e32 v136, v136
    v_rcp_f32_e32 v137, v137
    v_mfma_f32_32x32x16_bf16 v[160:175], a[136:139], v[120:123], v[160:175]
    s_cselect_b32 s100, s16, s18
    v_rcp_f32_e32 v138, v138
    v_rcp_f32_e32 v139, v139
    v_rcp_f32_e32 v140, v140
    v_mfma_f32_32x32x16_bf16 v[160:175], a[140:143], v[124:127], v[160:175]
    s_mov_b32 exec_hi, 0xffff
    buffer_store_dwordx4 v[52:55], v14, s[20:23], s74 offen offset:1536 sc1 nt
    buffer_store_dwordx4 v[68:71], v14, s[20:23], s74 offen offset:2304 sc1 nt
    s_mov_b32 exec_hi, -1
    v_rcp_f32_e32 v141, v141
    v_rcp_f32_e32 v142, v142
    v_rcp_f32_e32 v143, v143
    v_pk_mul_f32 v[144:145], v[144:145], v[128:129]
    v_pk_mul_f32 v[146:147], v[146:147], v[130:131]
    v_pk_mul_f32 v[148:149], v[148:149], v[132:133]
    v_pk_mul_f32 v[150:151], v[150:151], v[134:135]
    v_pk_mul_f32 v[152:153], v[152:153], v[136:137]
    v_pk_mul_f32 v[154:155], v[154:155], v[138:139]
    v_pk_mul_f32 v[156:157], v[156:157], v[140:141]
    v_pk_mul_f32 v[158:159], v[158:159], v[142:143]
    v_pk_fma_f32 v[128:129], v[160:161], v[160:161], s[32:33]
    v_pk_fma_f32 v[130:131], v[162:163], v[162:163], s[32:33]
    v_pk_fma_f32 v[132:133], v[164:165], v[164:165], s[32:33]
    v_pk_fma_f32 v[134:135], v[166:167], v[166:167], s[32:33]
    v_pk_fma_f32 v[136:137], v[168:169], v[168:169], s[32:33]
    v_pk_fma_f32 v[138:139], v[170:171], v[170:171], s[32:33]
    v_pk_fma_f32 v[140:141], v[172:173], v[172:173], s[32:33]
    v_pk_fma_f32 v[142:143], v[174:175], v[174:175], s[32:33]
    v_pk_mul_f32 v[128:129], v[128:129], v[160:161] neg_lo:[1,0] neg_hi:[1,0]
    v_pk_mul_f32 v[130:131], v[130:131], v[162:163] neg_lo:[1,0] neg_hi:[1,0]
    v_pk_mul_f32 v[132:133], v[132:133], v[164:165] neg_lo:[1,0] neg_hi:[1,0]
    v_pk_mul_f32 v[134:135], v[134:135], v[166:167] neg_lo:[1,0] neg_hi:[1,0]
    v_pk_mul_f32 v[136:137], v[136:137], v[168:169] neg_lo:[1,0] neg_hi:[1,0]
    v_pk_mul_f32 v[138:139], v[138:139], v[170:171] neg_lo:[1,0] neg_hi:[1,0]
    v_pk_mul_f32 v[140:141], v[140:141], v[172:173] neg_lo:[1,0] neg_hi:[1,0]
    v_pk_mul_f32 v[142:143], v[142:143], v[174:175] neg_lo:[1,0] neg_hi:[1,0]
    v_mfma_f32_32x32x16_bf16 v[176:191], v[28:31], v[60:63], v[176:191]
    s_cselect_b32 s101, s18, s16
    v_cvt_pk_bf16_f32 v144, v144, v145
    v_cvt_pk_bf16_f32 v145, v146, v147
    v_cvt_pk_bf16_f32 v146, v148, v149
    v_cvt_pk_bf16_f32 v147, v150, v151
    v_cvt_pk_bf16_f32 v148, v152, v153
    v_cvt_pk_bf16_f32 v149, v154, v155
    v_mfma_f32_32x32x16_bf16 v[208:223], a[248:251], v[144:147], v[208:223]
    s_sub_u32 s60, s17, s100
    ds_read_b32 v78, v22 offset:32
    ds_read_b128 v[104:107], v12
    ds_read_b128 v[108:111], v12 offset:1024
    ds_read_b128 v[112:115], v12 offset:2048
    v_cvt_pk_bf16_f32 v150, v156, v157
    v_cvt_pk_bf16_f32 v151, v158, v159
    v_mfma_f32_32x32x16_bf16 v[192:207], a[244:247], v[144:147], v[192:207]
    ds_read_b128 v[116:119], v12 offset:4096
    ds_read_b128 v[120:123], v12 offset:5120
    ds_read_b128 v[124:127], v12 offset:6144
    v_exp_f32_e32 v128, v128
    v_exp_f32_e32 v129, v129
    v_mfma_f32_32x32x16_bf16 v[176:191], a[240:243], v[144:147], v[176:191]
    v_exp_f32_e32 v130, v130
    v_exp_f32_e32 v131, v131
    v_exp_f32_e32 v132, v132
    v_mfma_f32_32x32x16_bf16 v[208:223], v[228:231], v[148:151], v[208:223]
    v_exp_f32_e32 v133, v133
    v_exp_f32_e32 v134, v134
    v_exp_f32_e32 v135, v135
    v_mfma_f32_32x32x16_bf16 v[192:207], v[224:227], v[148:151], v[192:207]
    s_waitcnt lgkmcnt(3)
    v_cmp_ne_u32_e32 vcc, v78, v79
    v_exp_f32_e32 v136, v136
    v_exp_f32_e32 v137, v137
    v_exp_f32_e32 v138, v138
    v_mfma_f32_32x32x16_bf16 v[176:191], a[252:255], v[148:151], v[176:191]
    s_cbranch_vccnz L_slow2
L_slow2_ret:
    v_exp_f32_e32 v139, v139
    v_exp_f32_e32 v140, v140
    v_exp_f32_e32 v141, v141
    v_exp_f32_e32 v142, v142
    v_exp_f32_e64 v143, v143
    v_pk_fma_f32 v[128:129], v[128:129], s[34:35], s[34:35]
    v_pk_fma_f32 v[130:131], v[130:131], s[34:35], s[34:35]
    v_pk_fma_f32 v[132:133], v[132:133], s[34:35], s[34:35]
    v_pk_fma_f32 v[134:135], v[134:135], s[34:35], s[34:35]
    v_pk_fma_f32 v[136:137], v[136:137], s[34:35], s[34:35]
    v_pk_fma_f32 v[138:139], v[138:139], s[34:35], s[34:35]
    v_pk_fma_f32 v[140:141], v[140:141], s[34:35], s[34:35]
    v_pk_fma_f32 v[142:143], v[142:143], s[34:35], s[34:35]
    v_mfma_f32_32x32x16_bf16 v[144:159], a[0:3], v[104:107], 0
    s_waitcnt lgkmcnt(0)
    v_rcp_f32_e32 v128, v128
    v_rcp_f32_e32 v129, v129
    v_rcp_f32_e32 v130, v130
    v_mfma_f32_32x32x16_bf16 v[144:159], a[4:7], v[108:111], v[144:159]
    v_rcp_f32_e32 v131, v131
    v_rcp_f32_e32 v132, v132
    v_rcp_f32_e32 v133, v133
    v_mfma_f32_32x32x16_bf16 v[144:159], a[8:11], v[112:115], v[144:159]
    s_sub_u32 s59, s49, s99
    v_rcp_f32_e32 v134, v134
    v_rcp_f32_e32 v135, v135
    v_rcp_f32_e32 v136, v136
    v_mfma_f32_32x32x16_bf16 v[144:159], a[12:15], v[116:119], v[144:159]
    s_sub_u32 s51, s51, 1
    v_rcp_f32_e32 v137, v137
    v_rcp_f32_e32 v138, v138
    v_rcp_f32_e32 v139, v139
    v_mfma_f32_32x32x16_bf16 v[144:159], a[16:19], v[120:123], v[144:159]
    s_cmp_lg_u32 s51, 0
    v_rcp_f32_e32 v140, v140
    v_rcp_f32_e32 v141, v141
    v_rcp_f32_e32 v142, v142
    v_mfma_f32_32x32x16_bf16 v[144:159], a[20:23], v[124:127], v[144:159]
    s_cbranch_scc1 L_loop
.p2align 3
    v_rcp_f32_e64 v143, v143
    v_pk_mul_f32 v[160:161], v[160:161], v[128:129]
    v_pk_mul_f32 v[162:163], v[162:163], v[130:131]
    v_pk_mul_f32 v[164:165], v[164:165], v[132:133]
    v_pk_mul_f32 v[166:167], v[166:167], v[134:135]
    v_pk_mul_f32 v[168:169], v[168:169], v[136:137]
    v_pk_mul_f32 v[170:171], v[170:171], v[138:139]
    v_pk_mul_f32 v[172:173], v[172:173], v[140:141]
    v_pk_mul_f32 v[174:175], v[174:175], v[142:143]
    s_nop 1
    v_pk_fma_f32 v[128:129], v[144:145], v[144:145], s[32:33]
    v_pk_fma_f32 v[130:131], v[146:147], v[146:147], s[32:33]
    v_pk_fma_f32 v[132:133], v[148:149], v[148:149], s[32:33]
    v_pk_fma_f32 v[134:135], v[150:151], v[150:151], s[32:33]
    v_pk_fma_f32 v[136:137], v[152:153], v[152:153], s[32:33]
    v_pk_fma_f32 v[138:139], v[154:155], v[154:155], s[32:33]
    v_pk_fma_f32 v[140:141], v[156:157], v[156:157], s[32:33]
    v_pk_fma_f32 v[142:143], v[158:159], v[158:159], s[32:33]
    v_pk_mul_f32 v[128:129], v[128:129], v[144:145] neg_lo:[1,0] neg_hi:[1,0]
    v_pk_mul_f32 v[130:131], v[130:131], v[146:147] neg_lo:[1,0] neg_hi:[1,0]
    v_pk_mul_f32 v[132:133], v[132:133], v[148:149] neg_lo:[1,0] neg_hi:[1,0]
    v_pk_mul_f32 v[134:135], v[134:135], v[150:151] neg_lo:[1,0] neg_hi:[1,0]
    v_pk_mul_f32 v[136:137], v[136:137], v[152:153] neg_lo:[1,0] neg_hi:[1,0]
    v_pk_mul_f32 v[138:139], v[138:139], v[154:155] neg_lo:[1,0] neg_hi:[1,0]
    v_pk_mul_f32 v[140:141], v[140:141], v[156:157] neg_lo:[1,0] neg_hi:[1,0]
    v_pk_mul_f32 v[142:143], v[142:143], v[158:159] neg_lo:[1,0] neg_hi:[1,0]
    v_cvt_pk_bf16_f32 v160, v160, v161
    v_cvt_pk_bf16_f32 v161, v162, v163
    v_cvt_pk_bf16_f32 v162, v164, v165
    v_cvt_pk_bf16_f32 v163, v166, v167
    v_cvt_pk_bf16_f32 v164, v168, v169
    v_cvt_pk_bf16_f32 v165, v170, v171
    v_mfma_f32_32x32x16_bf16 v[208:223], v[240:243], v[160:163], v[208:223]
    v_cvt_pk_bf16_f32 v166, v172, v173
    v_cvt_pk_bf16_f32 v167, v174, v175
    v_exp_f32_e32 v128, v128
    v_exp_f32_e32 v129, v129
    v_exp_f32_e32 v130, v130
    v_mfma_f32_32x32x16_bf16 v[208:223], v[252:255], v[164:167], v[208:223]
    v_exp_f32_e32 v131, v131
    v_exp_f32_e32 v132, v132
    v_exp_f32_e32 v133, v133
    v_exp_f32_e32 v134, v134
    v_mfma_f32_32x32x16_bf16 v[192:207], v[236:239], v[160:163], v[192:207]
    v_exp_f32_e32 v135, v135
    v_exp_f32_e32 v136, v136
    v_exp_f32_e32 v137, v137
    v_exp_f32_e32 v138, v138
    v_mfma_f32_32x32x16_bf16 v[192:207], v[248:251], v[164:167], v[192:207]
    v_exp_f32_e32 v139, v139
    v_exp_f32_e32 v140, v140
    v_cvt_pk_bf16_f32 v208, v208, v209
    v_cvt_pk_bf16_f32 v209, v210, v211
    v_cvt_pk_bf16_f32 v210, v212, v213
    v_cvt_pk_bf16_f32 v211, v214, v215
    v_mfma_f32_32x32x16_bf16 v[176:191], v[232:235], v[160:163], v[176:191]
    ds_write_b128 v10, v[208:211] offset:1024
    v_cvt_pk_bf16_f32 v212, v216, v217
    v_cvt_pk_bf16_f32 v213, v218, v219
    v_cvt_pk_bf16_f32 v214, v220, v221
    v_cvt_pk_bf16_f32 v215, v222, v223
    v_cvt_pk_bf16_f32 v200, v200, v201
    v_cvt_pk_bf16_f32 v201, v202, v203
    v_cvt_pk_bf16_f32 v202, v204, v205
    v_cvt_pk_bf16_f32 v203, v206, v207
    v_mfma_f32_32x32x16_bf16 v[176:191], v[244:247], v[164:167], v[176:191]
    ds_write_b128 v10, v[212:215] offset:2048
    v_exp_f32_e32 v141, v141
    v_exp_f32_e32 v142, v142
    v_exp_f32_e64 v143, v143
    v_pk_fma_f32 v[128:129], v[128:129], s[34:35], s[34:35]
    v_pk_fma_f32 v[130:131], v[130:131], s[34:35], s[34:35]
    v_pk_fma_f32 v[132:133], v[132:133], s[34:35], s[34:35]
    v_pk_fma_f32 v[134:135], v[134:135], s[34:35], s[34:35]
    v_pk_fma_f32 v[136:137], v[136:137], s[34:35], s[34:35]
    v_pk_fma_f32 v[138:139], v[138:139], s[34:35], s[34:35]
    v_pk_fma_f32 v[140:141], v[140:141], s[34:35], s[34:35]
    v_pk_fma_f32 v[142:143], v[142:143], s[34:35], s[34:35]
    v_mfma_f32_32x32x16_bf16 v[160:175], a[24:27], v[104:107], 0
    s_waitcnt lgkmcnt(1)
    ds_write_b128 v10, v[200:203]
    v_rcp_f32_e32 v128, v128
    v_mfma_f32_32x32x16_bf16 v[160:175], a[28:31], v[108:111], v[160:175]
    v_rcp_f32_e32 v129, v129
    v_rcp_f32_e32 v130, v130
    v_rcp_f32_e32 v131, v131
    v_mfma_f32_32x32x16_bf16 v[160:175], a[32:35], v[112:115], v[160:175]
    v_rcp_f32_e32 v132, v132
    v_rcp_f32_e32 v133, v133
    v_rcp_f32_e32 v134, v134
    v_mfma_f32_32x32x16_bf16 v[160:175], a[36:39], v[116:119], v[160:175]
    v_rcp_f32_e32 v135, v135
    v_rcp_f32_e32 v136, v136
    v_rcp_f32_e32 v137, v137
    v_rcp_f32_e32 v138, v138
    v_mfma_f32_32x32x16_bf16 v[160:175], a[40:43], v[120:123], v[160:175]
    s_waitcnt lgkmcnt(0)
    v_rcp_f32_e32 v139, v139
    v_rcp_f32_e32 v140, v140
    v_rcp_f32_e32 v141, v141
    v_mfma_f32_32x32x16_bf16 v[160:175], a[44:47], v[124:127], v[160:175]
    s_waitcnt lgkmcnt(0)
    s_barrier
    ds_read_b128 v[100:103], v11 offset:2048
    ds_read_b128 v[92:95], v11
    ds_read_b128 v[96:99], v11 offset:1024
    v_rcp_f32_e32 v142, v142
    v_rcp_f32_e32 v143, v143
    v_pk_mul_f32 v[144:145], v[144:145], v[128:129]
    v_pk_mul_f32 v[146:147], v[146:147], v[130:131]
    v_pk_mul_f32 v[148:149], v[148:149], v[132:133]
    v_pk_mul_f32 v[150:151], v[150:151], v[134:135]
    v_pk_mul_f32 v[152:153], v[152:153], v[136:137]
    v_pk_mul_f32 v[154:155], v[154:155], v[138:139]
    v_pk_mul_f32 v[156:157], v[156:157], v[140:141]
    v_pk_mul_f32 v[158:159], v[158:159], v[142:143]
    v_pk_fma_f32 v[128:129], v[160:161], v[160:161], s[32:33]
    v_pk_fma_f32 v[130:131], v[162:163], v[162:163], s[32:33]
    v_pk_fma_f32 v[132:133], v[164:165], v[164:165], s[32:33]
    v_pk_fma_f32 v[134:135], v[166:167], v[166:167], s[32:33]
    v_pk_fma_f32 v[136:137], v[168:169], v[168:169], s[32:33]
    v_pk_fma_f32 v[138:139], v[170:171], v[170:171], s[32:33]
    v_pk_fma_f32 v[140:141], v[172:173], v[172:173], s[32:33]
    v_pk_fma_f32 v[142:143], v[174:175], v[174:175], s[32:33]
    v_pk_mul_f32 v[128:129], v[128:129], v[160:161] neg_lo:[1,0] neg_hi:[1,0]
    v_pk_mul_f32 v[130:131], v[130:131], v[162:163] neg_lo:[1,0] neg_hi:[1,0]
    v_pk_mul_f32 v[132:133], v[132:133], v[164:165] neg_lo:[1,0] neg_hi:[1,0]
    v_pk_mul_f32 v[134:135], v[134:135], v[166:167] neg_lo:[1,0] neg_hi:[1,0]
    v_pk_mul_f32 v[136:137], v[136:137], v[168:169] neg_lo:[1,0] neg_hi:[1,0]
    v_pk_mul_f32 v[138:139], v[138:139], v[170:171] neg_lo:[1,0] neg_hi:[1,0]
    v_pk_mul_f32 v[140:141], v[140:141], v[172:173] neg_lo:[1,0] neg_hi:[1,0]
    v_pk_mul_f32 v[142:143], v[142:143], v[174:175] neg_lo:[1,0] neg_hi:[1,0]
    v_cvt_pk_bf16_f32 v144, v144, v145
    v_cvt_pk_bf16_f32 v145, v146, v147
    v_cvt_pk_bf16_f32 v146, v148, v149
    v_cvt_pk_bf16_f32 v147, v150, v151
    v_cvt_pk_bf16_f32 v148, v152, v153
    v_cvt_pk_bf16_f32 v149, v154, v155
    v_mfma_f32_32x32x16_bf16 v[208:223], a[152:155], v[144:147], 0
    s_waitcnt lgkmcnt(0)
    v_cvt_pk_bf16_f32 v150, v156, v157
    v_cvt_pk_bf16_f32 v151, v158, v159
    v_exp_f32_e32 v128, v128
    v_exp_f32_e32 v129, v129
    v_mfma_f32_32x32x16_bf16 v[208:223], a[164:167], v[148:151], v[208:223]
    v_exp_f32_e32 v130, v130
    v_exp_f32_e32 v131, v131
    v_exp_f32_e32 v132, v132
    v_mfma_f32_32x32x16_bf16 v[192:207], v[24:27], v[100:103], v[192:207]
    v_exp_f32_e32 v133, v133
    v_exp_f32_e32 v134, v134
    v_exp_f32_e32 v135, v135
    v_mfma_f32_32x32x16_bf16 v[176:191], v[24:27], v[92:95], v[176:191]
    v_exp_f32_e32 v136, v136
    v_exp_f32_e32 v137, v137
    v_exp_f32_e32 v138, v138
    v_mfma_f32_32x32x16_bf16 v[176:191], v[28:31], v[96:99], v[176:191]
    v_exp_f32_e32 v139, v139
    v_exp_f32_e32 v140, v140
    v_exp_f32_e32 v141, v141
    v_fma_f32 v128, v128, s34, s34
    v_cvt_pk_bf16_f32 v100, v192, v193
    v_cvt_pk_bf16_f32 v101, v194, v195
    v_cvt_pk_bf16_f32 v102, v196, v197
    v_cvt_pk_bf16_f32 v103, v198, v199
    v_mfma_f32_32x32x16_bf16 v[192:207], a[148:151], v[144:147], 0
    v_exp_f32_e32 v142, v142
    v_exp_f32_e64 v143, v143
    v_fma_f32 v129, v129, s34, s34
    v_cvt_pk_bf16_f32 v92, v176, v177
    v_mfma_f32_32x32x16_bf16 v[192:207], a[160:163], v[148:151], v[192:207]
    v_cvt_pk_bf16_f32 v93, v178, v179
    v_cvt_pk_bf16_f32 v94, v180, v181
    v_cvt_pk_bf16_f32 v95, v182, v183
    v_cvt_pk_bf16_f32 v96, v184, v185
    v_cvt_pk_bf16_f32 v97, v186, v187
    v_cvt_pk_bf16_f32 v98, v188, v189
    v_cvt_pk_bf16_f32 v99, v190, v191
    v_mfma_f32_32x32x16_bf16 v[176:191], a[144:147], v[144:147], 0
    ds_write_b128 v20, v[100:103] offset:64
    v_mfma_f32_32x32x16_bf16 v[176:191], a[156:159], v[148:151], v[176:191]
    ds_write_b128 v20, v[92:95]
    v_fma_f32 v130, v130, s34, s34
    v_fma_f32 v131, v131, s34, s34
    v_fma_f32 v132, v132, s34, s34
    v_fma_f32 v133, v133, s34, s34
    v_pk_fma_f32 v[134:135], v[134:135], s[34:35], s[34:35]
    v_pk_fma_f32 v[136:137], v[136:137], s[34:35], s[34:35]
    v_pk_fma_f32 v[138:139], v[138:139], s[34:35], s[34:35]
    v_pk_fma_f32 v[140:141], v[140:141], s[34:35], s[34:35]
    v_pk_fma_f32 v[142:143], v[142:143], s[34:35], s[34:35]
    v_mfma_f32_32x32x16_bf16 v[144:159], a[48:51], v[104:107], 0
    v_rcp_f32_e32 v128, v128
    v_rcp_f32_e32 v129, v129
    v_rcp_f32_e32 v130, v130
    v_mfma_f32_32x32x16_bf16 v[144:159], a[52:55], v[108:111], v[144:159]
    ds_write_b128 v20, v[96:99] offset:32
    v_mul_f32_e32 v160, v160, v128
    v_mfma_f32_32x32x16_bf16 v[144:159], a[56:59], v[112:115], v[144:159]
    s_waitcnt lgkmcnt(2)
    v_rcp_f32_e32 v131, v131
    v_rcp_f32_e32 v132, v132
    v_rcp_f32_e32 v133, v133
    v_mfma_f32_32x32x16_bf16 v[144:159], a[60:63], v[116:119], v[144:159]
    s_waitcnt lgkmcnt(1)
    v_rcp_f32_e32 v134, v134
    v_rcp_f32_e32 v135, v135
    v_rcp_f32_e32 v136, v136
    v_mfma_f32_32x32x16_bf16 v[144:159], a[64:67], v[120:123], v[144:159]
    v_rcp_f32_e32 v137, v137
    v_rcp_f32_e32 v138, v138
    v_rcp_f32_e32 v139, v139
    v_mfma_f32_32x32x16_bf16 v[144:159], a[68:71], v[124:127], v[144:159]
    v_rcp_f32_e32 v140, v140
    v_rcp_f32_e32 v141, v141
    v_rcp_f32_e32 v142, v142
    v_rcp_f32_e32 v143, v143
    v_mul_f32_e32 v161, v161, v129
    v_pk_mul_f32 v[162:163], v[162:163], v[130:131]
    v_pk_mul_f32 v[164:165], v[164:165], v[132:133]
    v_pk_mul_f32 v[166:167], v[166:167], v[134:135]
    v_pk_mul_f32 v[168:169], v[168:169], v[136:137]
    v_pk_mul_f32 v[170:171], v[170:171], v[138:139]
    v_pk_mul_f32 v[172:173], v[172:173], v[140:141]
    v_pk_mul_f32 v[174:175], v[174:175], v[142:143]
    v_pk_fma_f32 v[128:129], v[144:145], v[144:145], s[32:33]
    v_pk_fma_f32 v[130:131], v[146:147], v[146:147], s[32:33]
    v_pk_fma_f32 v[132:133], v[148:149], v[148:149], s[32:33]
    v_pk_fma_f32 v[134:135], v[150:151], v[150:151], s[32:33]
    v_pk_fma_f32 v[136:137], v[152:153], v[152:153], s[32:33]
    v_pk_fma_f32 v[138:139], v[154:155], v[154:155], s[32:33]
    v_pk_fma_f32 v[140:141], v[156:157], v[156:157], s[32:33]
    v_pk_fma_f32 v[142:143], v[158:159], v[158:159], s[32:33]
    v_pk_mul_f32 v[128:129], v[128:129], v[144:145] neg_lo:[1,0] neg_hi:[1,0]
    v_pk_mul_f32 v[130:131], v[130:131], v[146:147] neg_lo:[1,0] neg_hi:[1,0]
    v_pk_mul_f32 v[132:133], v[132:133], v[148:149] neg_lo:[1,0] neg_hi:[1,0]
    v_pk_mul_f32 v[134:135], v[134:135], v[150:151] neg_lo:[1,0] neg_hi:[1,0]
    v_pk_mul_f32 v[136:137], v[136:137], v[152:153] neg_lo:[1,0] neg_hi:[1,0]
    v_pk_mul_f32 v[138:139], v[138:139], v[154:155] neg_lo:[1,0] neg_hi:[1,0]
    v_pk_mul_f32 v[140:141], v[140:141], v[156:157] neg_lo:[1,0] neg_hi:[1,0]
    v_pk_mul_f32 v[142:143], v[142:143], v[158:159] neg_lo:[1,0] neg_hi:[1,0]
    v_cvt_pk_bf16_f32 v160, v160, v161
    v_cvt_pk_bf16_f32 v161, v162, v163
    v_cvt_pk_bf16_f32 v162, v164, v165
    v_cvt_pk_bf16_f32 v163, v166, v167
    v_cvt_pk_bf16_f32 v164, v168, v169
    v_cvt_pk_bf16_f32 v165, v170, v171
    v_mfma_f32_32x32x16_bf16 v[208:223], a[176:179], v[160:163], v[208:223]
    s_waitcnt lgkmcnt(0)
    v_cvt_pk_bf16_f32 v166, v172, v173
    v_cvt_pk_bf16_f32 v167, v174, v175
    v_exp_f32_e32 v128, v128
    v_exp_f32_e32 v129, v129
    v_mfma_f32_32x32x16_bf16 v[192:207], a[172:175], v[160:163], v[192:207]
    v_exp_f32_e32 v130, v130
    v_exp_f32_e32 v131, v131
    v_exp_f32_e32 v132, v132
    v_mfma_f32_32x32x16_bf16 v[176:191], a[168:171], v[160:163], v[176:191]
    v_exp_f32_e32 v133, v133
    v_exp_f32_e32 v134, v134
    v_exp_f32_e32 v135, v135
    v_mfma_f32_32x32x16_bf16 v[208:223], a[188:191], v[164:167], v[208:223]
    v_exp_f32_e32 v136, v136
    v_exp_f32_e32 v137, v137
    v_exp_f32_e32 v138, v138
    v_mfma_f32_32x32x16_bf16 v[192:207], a[184:187], v[164:167], v[192:207]
    v_exp_f32_e32 v139, v139
    v_exp_f32_e32 v140, v140
    v_exp_f32_e32 v141, v141
    v_mfma_f32_32x32x16_bf16 v[176:191], a[180:183], v[164:167], v[176:191]
    v_exp_f32_e32 v142, v142
    v_exp_f32_e64 v143, v143
    v_fma_f32 v128, v128, s34, s34
    v_fma_f32 v129, v129, s34, s34
    v_fma_f32 v130, v130, s34, s34
    v_fma_f32 v131, v131, s34, s34
    v_fma_f32 v132, v132, s34, s34
    v_fma_f32 v133, v133, s34, s34
    v_pk_fma_f32 v[134:135], v[134:135], s[34:35], s[34:35]
    v_pk_fma_f32 v[136:137], v[136:137], s[34:35], s[34:35]
    v_pk_fma_f32 v[138:139], v[138:139], s[34:35], s[34:35]
    v_pk_fma_f32 v[140:141], v[140:141], s[34:35], s[34:35]
    v_pk_fma_f32 v[142:143], v[142:143], s[34:35], s[34:35]
    v_mfma_f32_32x32x16_bf16 v[160:175], a[72:75], v[104:107], 0
    v_add_u32_e32 v78, s16, v21
    v_rcp_f32_e32 v128, v128
    v_rcp_f32_e32 v129, v129
    v_mul_f32_e32 v144, v144, v128
    v_mfma_f32_32x32x16_bf16 v[160:175], a[76:79], v[108:111], v[160:175]
    v_rcp_f32_e32 v130, v130
    v_rcp_f32_e32 v131, v131
    v_rcp_f32_e32 v132, v132
    v_mfma_f32_32x32x16_bf16 v[160:175], a[80:83], v[112:115], v[160:175]
    s_barrier
    ds_read2_b64 v[64:67], v78 offset0:8 offset1:9
    ds_read2_b64 v[56:59], v78 offset0:0 offset1:1
    ds_read2_b64 v[60:63], v78 offset0:4 offset1:5
    v_mfma_f32_32x32x16_bf16 v[160:175], a[84:87], v[116:119], v[160:175]
    v_rcp_f32_e32 v133, v133
    v_rcp_f32_e32 v134, v134
    v_rcp_f32_e32 v135, v135
    v_mfma_f32_32x32x16_bf16 v[160:175], a[88:91], v[120:123], v[160:175]
    s_mov_b32 s74, s43
    v_rcp_f32_e32 v136, v136
    v_rcp_f32_e32 v137, v137
    v_rcp_f32_e32 v138, v138
    v_rcp_f32_e32 v139, v139
    v_mfma_f32_32x32x16_bf16 v[160:175], a[92:95], v[124:127], v[160:175]
    s_waitcnt lgkmcnt(0)
    v_rcp_f32_e32 v140, v140
    v_rcp_f32_e32 v141, v141
    v_rcp_f32_e32 v142, v142
    v_rcp_f32_e32 v143, v143
    v_mul_f32_e32 v145, v145, v129
    v_pk_mul_f32 v[146:147], v[146:147], v[130:131]
    v_pk_mul_f32 v[148:149], v[148:149], v[132:133]
    v_pk_mul_f32 v[150:151], v[150:151], v[134:135]
    v_pk_mul_f32 v[152:153], v[152:153], v[136:137]
    v_pk_mul_f32 v[154:155], v[154:155], v[138:139]
    v_pk_mul_f32 v[156:157], v[156:157], v[140:141]
    v_pk_mul_f32 v[158:159], v[158:159], v[142:143]
    v_pk_fma_f32 v[128:129], v[160:161], v[160:161], s[32:33]
    v_pk_fma_f32 v[130:131], v[162:163], v[162:163], s[32:33]
    v_pk_fma_f32 v[132:133], v[164:165], v[164:165], s[32:33]
    v_pk_fma_f32 v[134:135], v[166:167], v[166:167], s[32:33]
    v_pk_fma_f32 v[136:137], v[168:169], v[168:169], s[32:33]
    v_pk_fma_f32 v[138:139], v[170:171], v[170:171], s[32:33]
    v_pk_fma_f32 v[140:141], v[172:173], v[172:173], s[32:33]
    v_pk_fma_f32 v[142:143], v[174:175], v[174:175], s[32:33]
    v_pk_mul_f32 v[128:129], v[128:129], v[160:161] neg_lo:[1,0] neg_hi:[1,0]
    v_pk_mul_f32 v[130:131], v[130:131], v[162:163] neg_lo:[1,0] neg_hi:[1,0]
    v_pk_mul_f32 v[132:133], v[132:133], v[164:165] neg_lo:[1,0] neg_hi:[1,0]
    v_pk_mul_f32 v[134:135], v[134:135], v[166:167] neg_lo:[1,0] neg_hi:[1,0]
    v_pk_mul_f32 v[136:137], v[136:137], v[168:169] neg_lo:[1,0] neg_hi:[1,0]
    v_pk_mul_f32 v[138:139], v[138:139], v[170:171] neg_lo:[1,0] neg_hi:[1,0]
    v_pk_mul_f32 v[140:141], v[140:141], v[172:173] neg_lo:[1,0] neg_hi:[1,0]
    v_pk_mul_f32 v[142:143], v[142:143], v[174:175] neg_lo:[1,0] neg_hi:[1,0]
    v_mfma_f32_32x32x16_bf16 v[192:207], v[24:27], v[64:67], v[192:207]
    s_mov_b32 s43, s44
    v_cvt_pk_bf16_f32 v144, v144, v145
    v_cvt_pk_bf16_f32 v145, v146, v147
    v_cvt_pk_bf16_f32 v146, v148, v149
    v_cvt_pk_bf16_f32 v147, v150, v151
    v_cvt_pk_bf16_f32 v148, v152, v153
    v_cvt_pk_bf16_f32 v149, v154, v155
    v_mfma_f32_32x32x16_bf16 v[208:223], a[200:203], v[144:147], v[208:223]
    s_mov_b32 s44, s45
    v_cvt_pk_bf16_f32 v150, v156, v157
    v_cvt_pk_bf16_f32 v151, v158, v159
    v_exp_f32_e32 v128, v128
    v_exp_f32_e32 v129, v129
    v_mfma_f32_32x32x16_bf16 v[192:207], a[196:199], v[144:147], v[192:207]
    s_mov_b32 s45, s46
    v_exp_f32_e32 v130, v130
    v_exp_f32_e32 v131, v131
    v_exp_f32_e32 v132, v132
    v_mfma_f32_32x32x16_bf16 v[176:191], a[192:195], v[144:147], v[176:191]
    s_mov_b32 s46, s47
    v_exp_f32_e32 v133, v133
    v_exp_f32_e32 v134, v134
    v_exp_f32_e32 v135, v135
    v_mfma_f32_32x32x16_bf16 v[208:223], a[212:215], v[148:151], v[208:223]
    s_mov_b32 s47, s48
    v_exp_f32_e32 v136, v136
    v_exp_f32_e32 v137, v137
    v_exp_f32_e32 v138, v138
    v_mfma_f32_32x32x16_bf16 v[192:207], a[208:211], v[148:151], v[192:207]
    v_exp_f32_e32 v139, v139
    v_exp_f32_e32 v140, v140
    v_exp_f32_e32 v141, v141
    v_mfma_f32_32x32x16_bf16 v[176:191], a[204:207], v[148:151], v[176:191]
    v_exp_f32_e32 v142, v142
    v_exp_f32_e64 v143, v143
    v_fma_f32 v128, v128, s34, s34
    v_fma_f32 v129, v129, s34, s34
    v_fma_f32 v130, v130, s34, s34
    v_fma_f32 v131, v131, s34, s34
    v_fma_f32 v132, v132, s34, s34
    v_fma_f32 v133, v133, s34, s34
    v_pk_fma_f32 v[134:135], v[134:135], s[34:35], s[34:35]
    v_pk_fma_f32 v[136:137], v[136:137], s[34:35], s[34:35]
    v_pk_fma_f32 v[138:139], v[138:139], s[34:35], s[34:35]
    v_pk_fma_f32 v[140:141], v[140:141], s[34:35], s[34:35]
    v_pk_fma_f32 v[142:143], v[142:143], s[34:35], s[34:35]
    v_mfma_f32_32x32x16_bf16 v[144:159], a[96:99], v[104:107], 0
    ds_read_b128 v[44:47], v10 offset:3072
    ds_read_b128 v[48:51], v10 offset:3856
    ds_read_b128 v[52:55], v10 offset:4640
    ds_read_b128 v[68:71], v10 offset:5424
    v_rcp_f32_e32 v128, v128
    v_mfma_f32_32x32x16_bf16 v[144:159], a[100:103], v[108:111], v[144:159]
    v_rcp_f32_e32 v129, v129
    v_rcp_f32_e32 v130, v130
    v_rcp_f32_e32 v131, v131
    v_mfma_f32_32x32x16_bf16 v[144:159], a[104:107], v[112:115], v[144:159]
    v_rcp_f32_e32 v132, v132
    v_rcp_f32_e32 v133, v133
    v_rcp_f32_e32 v134, v134
    v_mfma_f32_32x32x16_bf16 v[144:159], a[108:111], v[116:119], v[144:159]
    v_rcp_f32_e32 v135, v135
    v_rcp_f32_e32 v136, v136
    v_rcp_f32_e32 v137, v137
    v_mfma_f32_32x32x16_bf16 v[144:159], a[112:115], v[120:123], v[144:159]
    v_rcp_f32_e32 v138, v138
    v_rcp_f32_e32 v139, v139
    v_rcp_f32_e32 v140, v140
    v_mfma_f32_32x32x16_bf16 v[144:159], a[116:119], v[124:127], v[144:159]
    v_rcp_f32_e32 v141, v141
    v_rcp_f32_e32 v142, v142
    v_rcp_f32_e32 v143, v143
    v_mul_f32_e32 v160, v160, v128
    v_mul_f32_e32 v161, v161, v129
    v_mul_f32_e32 v162, v162, v130
    v_mul_f32_e32 v163, v163, v131
    v_pk_mul_f32 v[164:165], v[164:165], v[132:133]
    v_pk_mul_f32 v[166:167], v[166:167], v[134:135]
    v_pk_mul_f32 v[168:169], v[168:169], v[136:137]
    v_pk_mul_f32 v[170:171], v[170:171], v[138:139]
    v_pk_mul_f32 v[172:173], v[172:173], v[140:141]
    v_pk_mul_f32 v[174:175], v[174:175], v[142:143]
    v_pk_fma_f32 v[128:129], v[144:145], v[144:145], s[32:33]
    v_pk_fma_f32 v[130:131], v[146:147], v[146:147], s[32:33]
    v_pk_fma_f32 v[132:133], v[148:149], v[148:149], s[32:33]
    v_pk_fma_f32 v[134:135], v[150:151], v[150:151], s[32:33]
    v_pk_fma_f32 v[136:137], v[152:153], v[152:153], s[32:33]
    v_pk_fma_f32 v[138:139], v[154:155], v[154:155], s[32:33]
    v_pk_fma_f32 v[140:141], v[156:157], v[156:157], s[32:33]
    v_pk_fma_f32 v[142:143], v[158:159], v[158:159], s[32:33]
    v_pk_mul_f32 v[128:129], v[128:129], v[144:145] neg_lo:[1,0] neg_hi:[1,0]
    v_pk_mul_f32 v[130:131], v[130:131], v[146:147] neg_lo:[1,0] neg_hi:[1,0]
    v_pk_mul_f32 v[132:133], v[132:133], v[148:149] neg_lo:[1,0] neg_hi:[1,0]
    v_pk_mul_f32 v[134:135], v[134:135], v[150:151] neg_lo:[1,0] neg_hi:[1,0]
    v_pk_mul_f32 v[136:137], v[136:137], v[152:153] neg_lo:[1,0] neg_hi:[1,0]
    v_pk_mul_f32 v[138:139], v[138:139], v[154:155] neg_lo:[1,0] neg_hi:[1,0]
    v_pk_mul_f32 v[140:141], v[140:141], v[156:157] neg_lo:[1,0] neg_hi:[1,0]
    v_pk_mul_f32 v[142:143], v[142:143], v[158:159] neg_lo:[1,0] neg_hi:[1,0]
    v_mfma_f32_32x32x16_bf16 v[176:191], v[24:27], v[56:59], v[176:191]
    v_cvt_pk_bf16_f32 v160, v160, v161
    v_cvt_pk_bf16_f32 v161, v162, v163
    v_cvt_pk_bf16_f32 v162, v164, v165
    v_cvt_pk_bf16_f32 v163, v166, v167
    v_cvt_pk_bf16_f32 v164, v168, v169
    v_cvt_pk_bf16_f32 v165, v170, v171
    v_mfma_f32_32x32x16_bf16 v[208:223], a[224:227], v[160:163], v[208:223]
    v_cvt_pk_bf16_f32 v166, v172, v173
    v_cvt_pk_bf16_f32 v167, v174, v175
    v_exp_f32_e32 v128, v128
    v_exp_f32_e32 v129, v129
    v_mfma_f32_32x32x16_bf16 v[192:207], a[220:223], v[160:163], v[192:207]
    v_exp_f32_e32 v130, v130
    v_exp_f32_e32 v131, v131
    v_exp_f32_e32 v132, v132
    v_mfma_f32_32x32x16_bf16 v[176:191], a[216:219], v[160:163], v[176:191]
    v_exp_f32_e32 v133, v133
    v_exp_f32_e32 v134, v134
    v_exp_f32_e32 v135, v135
    v_mfma_f32_32x32x16_bf16 v[208:223], a[236:239], v[164:167], v[208:223]
    v_exp_f32_e32 v136, v136
    v_exp_f32_e32 v137, v137
    v_exp_f32_e32 v138, v138
    v_mfma_f32_32x32x16_bf16 v[192:207], a[232:235], v[164:167], v[192:207]
    v_exp_f32_e32 v139, v139
    v_exp_f32_e32 v140, v140
    v_exp_f32_e32 v141, v141
    v_mfma_f32_32x32x16_bf16 v[176:191], a[228:231], v[164:167], v[176:191]
    v_exp_f32_e32 v142, v142
    v_exp_f32_e32 v143, v143
    v_fma_f32 v128, v128, s34, s34
    v_fma_f32 v129, v129, s34, s34
    v_fma_f32 v130, v130, s34, s34
    v_fma_f32 v131, v131, s34, s34
    v_fma_f32 v132, v132, s34, s34
    v_fma_f32 v133, v133, s34, s34
    v_pk_fma_f32 v[134:135], v[134:135], s[34:35], s[34:35]
    v_pk_fma_f32 v[136:137], v[136:137], s[34:35], s[34:35]
    v_pk_fma_f32 v[138:139], v[138:139], s[34:35], s[34:35]
    v_pk_fma_f32 v[140:141], v[140:141], s[34:35], s[34:35]
    v_pk_fma_f32 v[142:143], v[142:143], s[34:35], s[34:35]
    v_mfma_f32_32x32x16_bf16 v[160:175], a[120:123], v[104:107], 0
    s_waitcnt lgkmcnt(0)
    v_rcp_f32_e32 v128, v128
    v_rcp_f32_e32 v129, v129
    v_rcp_f32_e32 v130, v130
    v_mfma_f32_32x32x16_bf16 v[160:175], a[124:127], v[108:111], v[160:175]
    s_mov_b32 exec_hi, 0xffff
    buffer_store_dwordx4 v[44:47], v14, s[20:23], s74 offen sc1 nt
    buffer_store_dwordx4 v[48:51], v14, s[20:23], s74 offen offset:768 sc1 nt
    s_mov_b32 exec_hi, -1
    v_rcp_f32_e32 v131, v131
    v_mfma_f32_32x32x16_bf16 v[160:175], a[128:131], v[112:115], v[160:175]
    v_rcp_f32_e32 v132, v132
    v_rcp_f32_e32 v133, v133
    v_rcp_f32_e32 v134, v134
    v_mfma_f32_32x32x16_bf16 v[160:175], a[132:135], v[116:119], v[160:175]
    v_rcp_f32_e32 v135, v135
    v_rcp_f32_e32 v136, v136
    v_rcp_f32_e32 v137, v137
    v_mfma_f32_32x32x16_bf16 v[160:175], a[136:139], v[120:123], v[160:175]
    v_rcp_f32_e32 v138, v138
    v_rcp_f32_e32 v139, v139
    v_rcp_f32_e32 v140, v140
    v_mfma_f32_32x32x16_bf16 v[160:175], a[140:143], v[124:127], v[160:175]
    s_mov_b32 exec_hi, 0xffff
    buffer_store_dwordx4 v[52:55], v14, s[20:23], s74 offen offset:1536 sc1 nt
    buffer_store_dwordx4 v[68:71], v14, s[20:23], s74 offen offset:2304 sc1 nt
    s_mov_b32 exec_hi, -1
    v_rcp_f32_e32 v141, v141
    v_rcp_f32_e32 v142, v142
    v_rcp_f32_e64 v143, v143
    v_pk_mul_f32 v[144:145], v[144:145], v[128:129]
    v_pk_mul_f32 v[146:147], v[146:147], v[130:131]
    v_pk_mul_f32 v[148:149], v[148:149], v[132:133]
    v_pk_mul_f32 v[150:151], v[150:151], v[134:135]
    v_pk_mul_f32 v[152:153], v[152:153], v[136:137]
    v_pk_mul_f32 v[154:155], v[154:155], v[138:139]
    v_pk_mul_f32 v[156:157], v[156:157], v[140:141]
    v_pk_mul_f32 v[158:159], v[158:159], v[142:143]
    v_pk_fma_f32 v[128:129], v[160:161], v[160:161], s[32:33]
    v_pk_fma_f32 v[130:131], v[162:163], v[162:163], s[32:33]
    v_pk_fma_f32 v[132:133], v[164:165], v[164:165], s[32:33]
    v_pk_fma_f32 v[134:135], v[166:167], v[166:167], s[32:33]
    v_pk_fma_f32 v[136:137], v[168:169], v[168:169], s[32:33]
    v_pk_fma_f32 v[138:139], v[170:171], v[170:171], s[32:33]
    v_pk_fma_f32 v[140:141], v[172:173], v[172:173], s[32:33]
    v_pk_fma_f32 v[142:143], v[174:175], v[174:175], s[32:33]
    v_pk_mul_f32 v[128:129], v[128:129], v[160:161] neg_lo:[1,0] neg_hi:[1,0]
    v_pk_mul_f32 v[130:131], v[130:131], v[162:163] neg_lo:[1,0] neg_hi:[1,0]
    v_pk_mul_f32 v[132:133], v[132:133], v[164:165] neg_lo:[1,0] neg_hi:[1,0]
    v_pk_mul_f32 v[134:135], v[134:135], v[166:167] neg_lo:[1,0] neg_hi:[1,0]
    v_pk_mul_f32 v[136:137], v[136:137], v[168:169] neg_lo:[1,0] neg_hi:[1,0]
    v_pk_mul_f32 v[138:139], v[138:139], v[170:171] neg_lo:[1,0] neg_hi:[1,0]
    v_pk_mul_f32 v[140:141], v[140:141], v[172:173] neg_lo:[1,0] neg_hi:[1,0]
    v_pk_mul_f32 v[142:143], v[142:143], v[174:175] neg_lo:[1,0] neg_hi:[1,0]
    v_mfma_f32_32x32x16_bf16 v[176:191], v[28:31], v[60:63], v[176:191]
    v_cvt_pk_bf16_f32 v144, v144, v145
    v_cvt_pk_bf16_f32 v145, v146, v147
    v_cvt_pk_bf16_f32 v146, v148, v149
    v_cvt_pk_bf16_f32 v147, v150, v151
    v_cvt_pk_bf16_f32 v148, v152, v153
    v_cvt_pk_bf16_f32 v149, v154, v155
    v_mfma_f32_32x32x16_bf16 v[208:223], a[248:251], v[144:147], v[208:223]
    v_cvt_pk_bf16_f32 v150, v156, v157
    v_cvt_pk_bf16_f32 v151, v158, v159
    v_exp_f32_e32 v128, v128
    v_exp_f32_e32 v129, v129
    v_mfma_f32_32x32x16_bf16 v[192:207], a[244:247], v[144:147], v[192:207]
    v_exp_f32_e32 v130, v130
    v_exp_f32_e32 v131, v131
    v_exp_f32_e32 v132, v132
    v_mfma_f32_32x32x16_bf16 v[176:191], a[240:243], v[144:147], v[176:191]
    v_exp_f32_e32 v133, v133
    v_exp_f32_e32 v134, v134
    v_exp_f32_e32 v135, v135
    v_mfma_f32_32x32x16_bf16 v[208:223], v[228:231], v[148:151], v[208:223]
    v_exp_f32_e32 v136, v136
    v_exp_f32_e32 v137, v137
    v_exp_f32_e32 v138, v138
    v_mfma_f32_32x32x16_bf16 v[192:207], v[224:227], v[148:151], v[192:207]
    v_exp_f32_e32 v139, v139
    v_exp_f32_e32 v140, v140
    v_exp_f32_e32 v141, v141
    v_mfma_f32_32x32x16_bf16 v[176:191], a[252:255], v[148:151], v[176:191]
    v_exp_f32_e32 v142, v142
    v_exp_f32_e32 v143, v143
    v_fma_f32 v128, v128, s34, s34
    v_fma_f32 v129, v129, s34, s34
    v_fma_f32 v130, v130, s34, s34
    v_fma_f32 v131, v131, s34, s34
    v_fma_f32 v132, v132, s34, s34
    v_fma_f32 v133, v133, s34, s34
    v_pk_fma_f32 v[134:135], v[134:135], s[34:35], s[34:35]
    v_pk_fma_f32 v[136:137], v[136:137], s[34:35], s[34:35]
    v_pk_fma_f32 v[138:139], v[138:139], s[34:35], s[34:35]
    v_pk_fma_f32 v[140:141], v[140:141], s[34:35], s[34:35]
    v_pk_fma_f32 v[142:143], v[142:143], s[34:35], s[34:35]
    v_rcp_f32_e32 v128, v128
    v_rcp_f32_e32 v129, v129
    v_rcp_f32_e32 v130, v130
    v_rcp_f32_e32 v131, v131
    v_rcp_f32_e32 v132, v132
    v_rcp_f32_e32 v133, v133
    v_rcp_f32_e32 v134, v134
    v_rcp_f32_e32 v135, v135
    v_rcp_f32_e64 v136, v136
    v_pk_mul_f32 v[160:161], v[160:161], v[128:129]
    v_pk_mul_f32 v[162:163], v[162:163], v[130:131]
    v_pk_mul_f32 v[164:165], v[164:165], v[132:133]
    v_pk_mul_f32 v[166:167], v[166:167], v[134:135]
    v_cvt_pk_bf16_f32 v160, v160, v161
    v_cvt_pk_bf16_f32 v161, v162, v163
    v_cvt_pk_bf16_f32 v162, v164, v165
    v_cvt_pk_bf16_f32 v163, v166, v167
    v_rcp_f32_e32 v137, v137
    v_rcp_f32_e32 v138, v138
    v_mfma_f32_32x32x16_bf16 v[208:223], v[240:243], v[160:163], v[208:223]
    v_rcp_f32_e32 v139, v139
    v_rcp_f32_e32 v140, v140
    v_rcp_f32_e32 v141, v141
    v_mfma_f32_32x32x16_bf16 v[192:207], v[236:239], v[160:163], v[192:207]
    v_rcp_f32_e32 v142, v142
    v_rcp_f32_e32 v143, v143
    v_mul_f32_e32 v168, v168, v136
    v_mul_f32_e32 v169, v169, v137
    v_mul_f32_e32 v170, v170, v138
    v_mul_f32_e32 v171, v171, v139
    v_mul_f32_e32 v172, v172, v140
    v_mul_f32_e32 v173, v173, v141
    v_mul_f32_e32 v174, v174, v142
    v_mul_f32_e32 v175, v175, v143
    v_cvt_pk_bf16_f32 v164, v168, v169
    v_cvt_pk_bf16_f32 v165, v170, v171
    v_cvt_pk_bf16_f32 v166, v172, v173
    v_cvt_pk_bf16_f32 v167, v174, v175
    s_nop 1
    v_mfma_f32_32x32x16_bf16 v[208:223], v[252:255], v[164:167], v[208:223]
    s_nop 6
    v_mfma_f32_32x32x16_bf16 v[192:207], v[248:251], v[164:167], v[192:207]
    s_nop 3
    v_cvt_pk_bf16_f32 v208, v208, v209
    v_cvt_pk_bf16_f32 v209, v210, v211
    v_cvt_pk_bf16_f32 v210, v212, v213
    v_cvt_pk_bf16_f32 v211, v214, v215
    v_mfma_f32_32x32x16_bf16 v[176:191], v[232:235], v[160:163], v[176:191]
    ds_write_b128 v10, v[208:211] offset:1024
    v_cvt_pk_bf16_f32 v212, v216, v217
    v_cvt_pk_bf16_f32 v213, v218, v219
    v_cvt_pk_bf16_f32 v214, v220, v221
    v_cvt_pk_bf16_f32 v215, v222, v223
    v_cvt_pk_bf16_f32 v200, v200, v201
    v_cvt_pk_bf16_f32 v201, v202, v203
    v_cvt_pk_bf16_f32 v202, v204, v205
    v_cvt_pk_bf16_f32 v203, v206, v207
    v_mfma_f32_32x32x16_bf16 v[176:191], v[244:247], v[164:167], v[176:191]
    ds_write_b128 v10, v[212:215] offset:2048
    ds_write_b128 v10, v[200:203]
    s_waitcnt lgkmcnt(0)
    s_barrier
    ds_read_b128 v[100:103], v11 offset:2048
    ds_read_b128 v[92:95], v11
    ds_read_b128 v[96:99], v11 offset:1024
    s_waitcnt lgkmcnt(2)
    v_mfma_f32_32x32x16_bf16 v[192:207], v[24:27], v[100:103], v[192:207]
    s_nop 5
    s_waitcnt lgkmcnt(1)
    v_mfma_f32_32x32x16_bf16 v[176:191], v[24:27], v[92:95], v[176:191]
    s_nop 3
    v_cvt_pk_bf16_f32 v100, v192, v193
    v_cvt_pk_bf16_f32 v101, v194, v195
    s_waitcnt lgkmcnt(0)
    v_mfma_f32_32x32x16_bf16 v[176:191], v[28:31], v[96:99], v[176:191]
    v_cvt_pk_bf16_f32 v102, v196, v197
    v_cvt_pk_bf16_f32 v103, v198, v199
    ds_write_b128 v20, v[100:103] offset:64
    s_nop 8
    v_cvt_pk_bf16_f32 v92, v176, v177
    v_cvt_pk_bf16_f32 v93, v178, v179
    v_cvt_pk_bf16_f32 v94, v180, v181
    v_cvt_pk_bf16_f32 v95, v182, v183
    ds_write_b128 v20, v[92:95]
    v_cvt_pk_bf16_f32 v96, v184, v185
    v_cvt_pk_bf16_f32 v97, v186, v187
    v_cvt_pk_bf16_f32 v98, v188, v189
    v_cvt_pk_bf16_f32 v99, v190, v191
    ds_write_b128 v20, v[96:99] offset:32
    s_waitcnt lgkmcnt(0)
    s_barrier
    ds_read_b128 v[44:47], v10 offset:3072
    ds_read_b128 v[48:51], v10 offset:3856
    ds_read_b128 v[52:55], v10 offset:4640
    ds_read_b128 v[68:71], v10 offset:5424
    s_mov_b32 exec_hi, 0xffff
    s_waitcnt lgkmcnt(3)
    buffer_store_dwordx4 v[44:47], v14, s[20:23], s43 offen sc1 nt
    s_waitcnt lgkmcnt(2)
    buffer_store_dwordx4 v[48:51], v14, s[20:23], s43 offen offset:768 sc1 nt
    s_waitcnt lgkmcnt(1)
    buffer_store_dwordx4 v[52:55], v14, s[20:23], s43 offen offset:1536 sc1 nt
    s_waitcnt lgkmcnt(0)
    buffer_store_dwordx4 v[68:71], v14, s[20:23], s43 offen offset:2304 sc1 nt
    s_mov_b32 exec_hi, -1
L_end:
    s_endpgm
L_border:
    s_cmp_eq_u32 s59, 1
    s_cselect_b32 exec_lo, -1, 0
    s_mov_b32 exec_hi, 0
    v_mov_b32_e32 v0, 0xe180
    v_mov_b32_e32 v1, 0xe180
    s_cmp_eq_u32 s59, 0
    s_cselect_b64 exec, -1, 0
    v_mov_b32_e32 v2, 0xe180
    v_mov_b32_e32 v3, 0xe180
    s_mov_b64 exec, -1
    s_branch L_border_ret
L_borderf:
    s_cmp_eq_u32 s59, 1
    s_cselect_b32 exec_lo, -1, 0
    s_mov_b32 exec_hi, 0
    v_mov_b32_e32 v0, 0xe180
    v_mov_b32_e32 v1, 0xe180
    s_cmp_eq_u32 s59, 0
    s_cselect_b64 exec, -1, 0
    v_mov_b32_e32 v2, 0xe180
    v_mov_b32_e32 v3, 0xe180
    s_mov_b64 exec, -1
    s_branch L_border_retf
L_slow0:
    ds_read_b32 v78, v22
    s_waitcnt lgkmcnt(0)
    v_cmp_ne_u32_e32 vcc, v78, v79
    s_nop 3
    s_cbranch_vccnz L_slow0
    ds_read_b128 v[100:103], v11 offset:2048
    ds_read_b128 v[92:95], v11
    ds_read_b128 v[96:99], v11 offset:1024
    s_waitcnt lgkmcnt(0)
    s_nop 1
    s_branch L_slow0_ret
L_slow1:
    ds_read_b32 v78, v22 offset:16
    s_waitcnt lgkmcnt(0)
    v_cmp_ne_u32_e32 vcc, v78, v79
    s_nop 3
    s_cbranch_vccnz L_slow1
    ds_read2st64_b64 v[44:47], v14 offset0:6 offset1:14
    ds_read2st64_b64 v[48:51], v14 offset0:22 offset1:30
    s_waitcnt lgkmcnt(0)
    s_nop 1
    s_branch L_slow1_ret
L_slow2:
    ds_read_b32 v78, v22 offset:32
    s_waitcnt lgkmcnt(0)
    v_cmp_ne_u32_e32 vcc, v78, v79
    s_nop 3
    s_cbranch_vccnz L_slow2
    ds_read_b128 v[104:107], v12
    ds_read_b128 v[108:111], v12 offset:1024
    ds_read_b128 v[112:115], v12 offset:2048
    ds_read_b128 v[116:119], v12 offset:4096
    ds_read_b128 v[120:123], v12 offset:5120
    ds_read_b128 v[124:127], v12 offset:6144
    s_waitcnt lgkmcnt(0)
    s_nop 1
    s_branch L_slow2_ret
L_code_end:
.section .rodata,"a"
.p2align 6
.amdhsa_kernel standalone__modern_conv_block_replknet__vision_kernel
  .amdhsa_next_free_vgpr 512
  .amdhsa_next_free_sgpr 102
  .amdhsa_accum_offset 256
  .amdhsa_group_segment_fixed_size 0
  .amdhsa_kernarg_size 64
  .amdhsa_user_sgpr_count 2
  .amdhsa_user_sgpr_kernarg_segment_ptr 1
  .amdhsa_system_sgpr_workgroup_id_x 1
.end_amdhsa_kernel
```
